```python
import torch

def _softmax(x, axis=-1):
    return torch.softmax(x, dim=axis)
def _gelu(x):
    return torch.nn.functional.gelu(x, approximate="tanh")
def _silu(x):
    return torch.nn.functional.silu(x)
def _sigmoid(x):
    return torch.sigmoid(x)
def _layernorm(x, axis=-1, eps=1e-5):
    m = x.mean(dim=axis, keepdim=True)
    v = x.var(dim=axis, keepdim=True, unbiased=False)
    return (x - m) / torch.sqrt(v + eps)
def _scatter_add(tgt, idx, src, axis=0):
    return tgt.clone().index_add_(axis, idx, src)
def _segment_sum(src, seg, n):
    out = torch.zeros((n,) + src.shape[1:], dtype=src.dtype)
    return out.index_add_(0, seg, src)
def _pad(x, pw):
    flat = tuple(v for pair in reversed(pw) for v in pair)
    return torch.nn.functional.pad(x, flat)

kernel_name = 'gated_mix__gqa_block_cached__dense_activation_squared_relu__decode'

def setup_inputs():

    _w = (lambda a: (lambda t: t.to(torch.bfloat16) if t.is_floating_point() else t)(torch.as_tensor(a)))
    def _A_setup():
        B, Sq, D = 8, 1, 512
        Hq, Hkv, Sk, Dh = 32, 8, 4096, 128
        assert Hq % Hkv == 0, (Hq, Hkv)
        return {
            "x": _w((lambda *s: torch.randn(*s, dtype=torch.bfloat16) * 0.05)(B, Sq, D)),
            "k_cache": _w((lambda *s: torch.randn(*s, dtype=torch.bfloat16) * 6.4)(B, Hkv, Sk, Dh)),
            "v_cache": _w((lambda *s: torch.randn(*s, dtype=torch.bfloat16) * 0.4)(B, Hkv, Sk, Dh)),
            "wq": _w((lambda *s: torch.randn(*s, dtype=torch.bfloat16) * 6.4)(D, Hq * Dh) * (D ** -0.5)),
            "wo": _w((lambda *s: torch.randn(*s, dtype=torch.bfloat16) * 0.4)(Hq * Dh, D) * ((Hq * Dh) ** -0.5)),
        }
    _A_in = _A_setup()

    def _B_setup():
        B, S, D, F = 8, 1, 512, 1792
        return {
            "x": _w((lambda *s: torch.randn(*s, dtype=torch.bfloat16) * 0.05)(B, S, D)),
            "w1": _w((lambda *s: torch.randn(*s, dtype=torch.bfloat16) * 0.05)(D, F)),
            "b1": _w((lambda *s: torch.randn(*s, dtype=torch.bfloat16) * 0.05)(F)),
            "w2": _w((lambda *s: torch.randn(*s, dtype=torch.bfloat16) * 0.05)(F, D)),
            "b2": _w((lambda *s: torch.randn(*s, dtype=torch.bfloat16) * 0.05)(D)),
        }
    _B_in = _B_setup()

    return {
        "A_x": _A_in["x"],
        "A_k_cache": _A_in["k_cache"],
        "A_v_cache": _A_in["v_cache"],
        "A_wq": _A_in["wq"],
        "A_wo": _A_in["wo"],
        "B_x": _B_in["x"],
        "B_w1": _B_in["w1"],
        "B_b1": _B_in["b1"],
        "B_w2": _B_in["w2"],
        "B_b2": _B_in["b2"],
        "gate_w": _w((lambda *s: torch.randn(*s, dtype=torch.bfloat16) * 0.05)(512) * 16.0),
    }

def reference(A_x, A_k_cache, A_v_cache, A_wq, A_wo, B_x, B_w1, B_b1, B_w2, B_b2, gate_w):
    def _A_ref(x, k_cache, v_cache, wq, wo):
        B, Sq, D = x.shape
        Hq, Dh = 32, 128
        Hkv = k_cache.shape[1]
        rep = Hq // Hkv
        q = (lambda x, *d: x.permute(*d))((x @ wq).reshape(B, Sq, Hq, Dh), 0, 2, 1, 3)
        k = (lambda x, n, axis: torch.repeat_interleave(x, n, dim=axis))(k_cache, rep, axis=1)
        v = (lambda x, n, axis: torch.repeat_interleave(x, n, dim=axis))(v_cache, rep, axis=1)
        scores = torch.einsum("bhqd,bhkd->bhqk", q, k) * (Dh ** -0.5)
        p = _softmax(scores, axis=-1)
        o = torch.einsum("bhqk,bhkd->bhqd", p, v)
        return (lambda x, *d: x.permute(*d))(o, 0, 2, 1, 3).reshape(B, Sq, Hq * Dh) @ wo

    def _B_ref(x, w1, b1, w2, b2):
        h = torch.einsum("bsd,df->bsf", x, w1) + b1
        zero = torch.zeros_like(h)
        r = torch.where(h > zero, h, zero)
        h = r * r
        out = torch.einsum("bsf,fd->bsd", h, w2) + b2
        return out

    x = A_x
    g = _sigmoid((x * gate_w).sum(-1, keepdims=True))
    a = _A_ref(x, A_k_cache, A_v_cache, A_wq, A_wo)
    b = _B_ref(x, B_w1, B_b1, B_w2, B_b2)
    return g * a + (1 - g) * b
```

```asm
; @launch grid=(256,1,1) block=(512,1,1) lds=59392
.amdgcn_target "amdgcn-amd-amdhsa--gfx950"
.text
.globl gated_mix__gqa_block_cached__dense_activation_squared_relu__decode_kernel
.p2align 8
.type gated_mix__gqa_block_cached__dense_activation_squared_relu__decode_kernel,@function
gated_mix__gqa_block_cached__dense_activation_squared_relu__decode_kernel:
    s_cmp_ge_u32 s2, 256
    s_cbranch_scc1 L_end
    s_load_dwordx16 s[16:31], s[0:1], 0
    s_load_dwordx8 s[32:39], s[0:1], 64
    s_load_dwordx4 s[40:43], s[0:1], 96
    v_lshrrev_b32 v3, 6, v0
    v_and_b32 v0, 63, v0
    v_readfirstlane_b32 s3, v3
    v_mov_b32 v4, 0
    v_mov_b32 v5, 0
    v_mov_b32 v6, 0
    v_mov_b32 v7, 0
    ds_write_b128 v4, v[4:7]
    s_add_u32 s3, s3, 7
    s_and_b32 s3, s3, 7
    s_and_b32 s48, s2, 7
    s_lshr_b32 s49, s2, 3
    s_mov_b32 s50, s48
    s_lshr_b32 s51, s49, 2
    s_and_b32 s52, s49, 3
    s_lshl_b32 s66, s48, 5
    s_add_u32 s66, s66, s49
    s_lshl_b32 s53, s66, 18
    s_mul_i32 s56, s3, 4096
    s_add_u32 s56, s56, s53
    s_mov_b32 s57, s56
    v_bfe_u32 v3, v0, 2, 2
    v_lshlrev_b32 v1, 8, v3
    v_lshrrev_b32 v3, 4, v0
    v_lshl_add_u32 v1, v3, 6, v1
    v_and_b32 v3, 3, v0
    v_lshl_add_u32 v1, v3, 4, v1
    v_lshlrev_b32 v2, 4, v0
    s_mov_b32 s6, 0x4000000
    s_mov_b32 s7, 0x20000
    s_mov_b32 s10, 0x4000000
    s_mov_b32 s11, 0x20000
    s_mov_b32 s14, 0x10000000
    s_mov_b32 s15, 0x20000
    s_mov_b32 s47, 0x20000
    s_mov_b32 s68, 1035273459
    s_mov_b32 s69, 1069066811
    s_mov_b32 s70, 0xffff0000
    s_cmp_eq_u32 s3, 7
    s_waitcnt lgkmcnt(0)
    s_mov_b32 s4, s18
    s_mov_b32 s5, s19
    s_mov_b32 s8, s20
    s_mov_b32 s9, s21
    s_mov_b32 s12, s42
    s_mov_b32 s13, s43
    s_cbranch_scc1 L_service
    buffer_load_dwordx4 v[52:55], v1, s[4:7], s56 offen offset:0 nt
    buffer_load_dwordx4 v[56:59], v1, s[4:7], s56 offen offset:1024 nt
    buffer_load_dwordx4 v[60:63], v1, s[4:7], s56 offen offset:2048 nt
    v_and_b32 v3, 1, v0
    v_cmp_eq_u32 vcc, 0, v3
    v_mov_b32 v22, 0x0c0c0100
    v_mov_b32 v23, 0x0c0c0302
    v_mov_b32 v24, 0x01000c0c
    v_mov_b32 v25, 0x03020c0c
    v_cndmask_b32 v22, v24, v22, vcc
    v_cndmask_b32 v23, v25, v23, vcc
    v_and_b32 v3, 2, v0
    v_cmp_eq_u32 vcc, 0, v3
    v_mov_b32 v24, 0x0c0c0c0c
    v_mov_b32 v20, 0xff800000
    v_cndmask_b32 v8, v24, v22, vcc
    v_cndmask_b32 v9, v22, v24, vcc
    v_cndmask_b32 v10, v24, v23, vcc
    v_cndmask_b32 v11, v23, v24, vcc
    v_mov_b32 v12, 0
    v_mov_b32 v13, 0
    v_mov_b32 v14, 0
    v_mov_b32 v15, 0
    v_mov_b32 v16, 0
    v_mov_b32 v17, 0
    v_mov_b32 v18, 0
    v_mov_b32 v19, 0
    v_mov_b32 v21, 0
    s_barrier
    s_waitcnt vmcnt(2)
    buffer_load_dwordx4 v[64:67], v1, s[4:7], s56 offen offset:3072 nt
    s_add_u32 s56, s56, 28672
    s_waitcnt vmcnt(2)
    buffer_load_dwordx4 v[68:71], v1, s[4:7], s56 offen offset:0 nt
    s_waitcnt vmcnt(2)
    buffer_load_dwordx4 v[72:75], v1, s[4:7], s56 offen offset:1024 nt
    s_waitcnt vmcnt(2)
    buffer_load_dwordx4 v[76:79], v1, s[4:7], s56 offen offset:2048 nt
    s_waitcnt vmcnt(2)
    buffer_load_dwordx4 v[80:83], v1, s[4:7], s56 offen offset:3072 nt
    s_add_u32 s56, s56, 28672
    s_waitcnt vmcnt(2)
    buffer_load_dwordx4 v[84:87], v1, s[4:7], s56 offen offset:0 nt
    s_waitcnt vmcnt(2)
    buffer_load_dwordx4 v[88:91], v1, s[4:7], s56 offen offset:1024 nt
    s_waitcnt vmcnt(2)
    buffer_load_dwordx4 v[92:95], v1, s[4:7], s56 offen offset:2048 nt
    s_waitcnt vmcnt(2)
    buffer_load_dwordx4 v[96:99], v1, s[4:7], s56 offen offset:3072 nt
    s_add_u32 s56, s56, 28672
    s_waitcnt vmcnt(2)
    buffer_load_dwordx4 v[100:103], v1, s[4:7], s56 offen offset:0 nt
    s_waitcnt vmcnt(2)
    buffer_load_dwordx4 v[104:107], v1, s[4:7], s56 offen offset:1024 nt
    s_waitcnt vmcnt(2)
    buffer_load_dwordx4 v[108:111], v1, s[4:7], s56 offen offset:2048 nt
    s_waitcnt vmcnt(2)
    buffer_load_dwordx4 v[112:115], v1, s[4:7], s56 offen offset:3072 nt
    s_add_u32 s56, s56, 28672
    s_waitcnt vmcnt(2)
    buffer_load_dwordx4 v[116:119], v1, s[4:7], s56 offen offset:0 nt
    s_waitcnt vmcnt(2)
    buffer_load_dwordx4 v[120:123], v1, s[4:7], s56 offen offset:1024 nt
    s_waitcnt vmcnt(2)
    buffer_load_dwordx4 v[124:127], v1, s[4:7], s56 offen offset:2048 nt
    s_waitcnt vmcnt(2)
    buffer_load_dwordx4 v[128:131], v1, s[4:7], s56 offen offset:3072 nt
    s_add_u32 s56, s56, 28672
    s_waitcnt vmcnt(2)
    buffer_load_dwordx4 v[132:135], v1, s[4:7], s56 offen offset:0 nt
    s_waitcnt vmcnt(2)
    buffer_load_dwordx4 v[136:139], v1, s[4:7], s56 offen offset:1024 nt
    s_waitcnt vmcnt(2)
    buffer_load_dwordx4 v[140:143], v1, s[4:7], s56 offen offset:2048 nt
    s_waitcnt vmcnt(2)
    buffer_load_dwordx4 v[144:147], v1, s[4:7], s56 offen offset:3072 nt
    s_add_u32 s56, s56, 28672
    s_waitcnt vmcnt(2)
    buffer_load_dwordx4 v[148:151], v1, s[4:7], s56 offen offset:0 nt
    s_waitcnt vmcnt(2)
    buffer_load_dwordx4 v[152:155], v1, s[4:7], s56 offen offset:1024 nt
    s_waitcnt vmcnt(2)
    buffer_load_dwordx4 v[156:159], v1, s[4:7], s56 offen offset:2048 nt
    s_waitcnt vmcnt(2)
    buffer_load_dwordx4 v[160:163], v1, s[4:7], s56 offen offset:3072 nt
    s_add_u32 s56, s56, 28672
    s_waitcnt vmcnt(2)
    buffer_load_dwordx4 v[164:167], v1, s[4:7], s56 offen offset:0 nt
    s_waitcnt vmcnt(2)
    buffer_load_dwordx4 v[168:171], v1, s[4:7], s56 offen offset:1024 nt
    s_waitcnt vmcnt(2)
    buffer_load_dwordx4 v[172:175], v1, s[4:7], s56 offen offset:2048 nt
    s_waitcnt vmcnt(2)
    buffer_load_dwordx4 v[176:179], v1, s[4:7], s56 offen offset:3072 nt
    s_add_u32 s56, s56, 28672
    s_waitcnt vmcnt(2)
    buffer_load_dwordx4 v[180:183], v1, s[4:7], s56 offen offset:0 nt
    s_waitcnt vmcnt(2)
    buffer_load_dwordx4 v[184:187], v1, s[4:7], s56 offen offset:1024 nt
    s_waitcnt vmcnt(2)
    buffer_load_dwordx4 v[188:191], v1, s[4:7], s56 offen offset:2048 nt
    s_waitcnt vmcnt(2)
    buffer_load_dwordx4 v[192:195], v1, s[4:7], s56 offen offset:3072 nt
    s_waitcnt vmcnt(2)
    buffer_load_dwordx4 v[196:199], v2, s[8:11], s57 offen offset:0 nt
    s_waitcnt vmcnt(2)
    buffer_load_dwordx4 v[200:203], v2, s[8:11], s57 offen offset:1024 nt
    v_mov_b32 v3, 0
    s_mov_b32 s66, 0
L_qw:
    ds_read_b32 v22, v3 offset:0
    s_add_u32 s66, s66, 1
    s_waitcnt lgkmcnt(0)
    s_cmp_gt_u32 s66, 1600000
    s_cbranch_scc1 L_qwgo
    v_readfirstlane_b32 s67, v22
    s_nop 0
    s_cmp_eq_u32 s67, 1
    s_cbranch_scc1 L_qwgo
    s_sleep 1
    s_branch L_qw
L_qwgo:
    ds_read_b128 v[4:7], v1 offset:1024
    buffer_load_dwordx4 v[204:207], v2, s[8:11], s57 offen offset:2048 nt
    s_waitcnt lgkmcnt(0)
    s_waitcnt vmcnt(35)
    v_mfma_f32_16x16x32_bf16 v[52:55], v[52:55], v[4:7], 0
    v_mfma_f32_16x16x32_bf16 v[56:59], v[56:59], v[4:7], 0
    v_mfma_f32_16x16x32_bf16 v[60:63], v[60:63], v[4:7], 0
    v_mfma_f32_16x16x32_bf16 v[64:67], v[64:67], v[4:7], 0
    buffer_load_dwordx4 v[208:211], v2, s[8:11], s57 offen offset:3072 nt
    s_add_u32 s57, s57, 28672
    s_waitcnt vmcnt(32)
    v_mfma_f32_16x16x32_bf16 v[68:71], v[68:71], v[4:7], 0
    v_mfma_f32_16x16x32_bf16 v[72:75], v[72:75], v[4:7], 0
    v_mfma_f32_16x16x32_bf16 v[76:79], v[76:79], v[4:7], 0
    v_mfma_f32_16x16x32_bf16 v[80:83], v[80:83], v[4:7], 0
    s_nop 3
    v_mov_b32_dpp v22, v52 quad_perm:[0,0,0,0] row_mask:0xf bank_mask:0xf
    v_mov_b32_dpp v23, v56 quad_perm:[0,0,0,0] row_mask:0xf bank_mask:0xf
    v_mov_b32_dpp v24, v60 quad_perm:[0,0,0,0] row_mask:0xf bank_mask:0xf
    v_mov_b32_dpp v25, v64 quad_perm:[0,0,0,0] row_mask:0xf bank_mask:0xf
    v_add_f32_dpp v22, v53, v22 quad_perm:[1,1,1,1] row_mask:0xf bank_mask:0xf
    v_add_f32_dpp v23, v57, v23 quad_perm:[1,1,1,1] row_mask:0xf bank_mask:0xf
    v_add_f32_dpp v24, v61, v24 quad_perm:[1,1,1,1] row_mask:0xf bank_mask:0xf
    v_add_f32_dpp v25, v65, v25 quad_perm:[1,1,1,1] row_mask:0xf bank_mask:0xf
    v_add_f32_dpp v22, v54, v22 quad_perm:[2,2,2,2] row_mask:0xf bank_mask:0xf
    v_add_f32_dpp v23, v58, v23 quad_perm:[2,2,2,2] row_mask:0xf bank_mask:0xf
    v_add_f32_dpp v24, v62, v24 quad_perm:[2,2,2,2] row_mask:0xf bank_mask:0xf
    v_add_f32_dpp v25, v66, v25 quad_perm:[2,2,2,2] row_mask:0xf bank_mask:0xf
    v_add_f32_dpp v22, v55, v22 quad_perm:[3,3,3,3] row_mask:0xf bank_mask:0xf
    v_add_f32_dpp v23, v59, v23 quad_perm:[3,3,3,3] row_mask:0xf bank_mask:0xf
    v_add_f32_dpp v24, v63, v24 quad_perm:[3,3,3,3] row_mask:0xf bank_mask:0xf
    v_add_f32_dpp v25, v67, v25 quad_perm:[3,3,3,3] row_mask:0xf bank_mask:0xf
    buffer_load_dwordx4 v[212:215], v2, s[8:11], s57 offen offset:0 nt
    v_cvt_pk_bf16_f32 v26, v22, v23
    v_cvt_pk_bf16_f32 v27, v24, v25
    v_lshlrev_b32 v22, 16, v26
    v_and_b32 v23, s70, v26
    v_lshlrev_b32 v24, 16, v27
    v_and_b32 v25, s70, v27
    v_mul_f32 v22, s68, v22
    v_mul_f32 v23, s68, v23
    v_mul_f32 v24, s68, v24
    v_mul_f32 v25, s68, v25
    v_cvt_pk_bf16_f32 v32, v22, v23
    v_cvt_pk_bf16_f32 v33, v24, v25
    v_max3_f32 v20, v20, v22, v23
    v_max3_f32 v20, v20, v24, v25
    s_waitcnt vmcnt(29)
    v_mfma_f32_16x16x32_bf16 v[84:87], v[84:87], v[4:7], 0
    v_mfma_f32_16x16x32_bf16 v[88:91], v[88:91], v[4:7], 0
    v_mfma_f32_16x16x32_bf16 v[92:95], v[92:95], v[4:7], 0
    v_mfma_f32_16x16x32_bf16 v[96:99], v[96:99], v[4:7], 0
    v_mov_b32_dpp v22, v68 quad_perm:[0,0,0,0] row_mask:0xf bank_mask:0xf
    v_mov_b32_dpp v23, v72 quad_perm:[0,0,0,0] row_mask:0xf bank_mask:0xf
    v_mov_b32_dpp v24, v76 quad_perm:[0,0,0,0] row_mask:0xf bank_mask:0xf
    v_mov_b32_dpp v25, v80 quad_perm:[0,0,0,0] row_mask:0xf bank_mask:0xf
    v_add_f32_dpp v22, v69, v22 quad_perm:[1,1,1,1] row_mask:0xf bank_mask:0xf
    v_add_f32_dpp v23, v73, v23 quad_perm:[1,1,1,1] row_mask:0xf bank_mask:0xf
    v_add_f32_dpp v24, v77, v24 quad_perm:[1,1,1,1] row_mask:0xf bank_mask:0xf
    v_add_f32_dpp v25, v81, v25 quad_perm:[1,1,1,1] row_mask:0xf bank_mask:0xf
    v_add_f32_dpp v22, v70, v22 quad_perm:[2,2,2,2] row_mask:0xf bank_mask:0xf
    v_add_f32_dpp v23, v74, v23 quad_perm:[2,2,2,2] row_mask:0xf bank_mask:0xf
    v_add_f32_dpp v24, v78, v24 quad_perm:[2,2,2,2] row_mask:0xf bank_mask:0xf
    v_add_f32_dpp v25, v82, v25 quad_perm:[2,2,2,2] row_mask:0xf bank_mask:0xf
    v_add_f32_dpp v22, v71, v22 quad_perm:[3,3,3,3] row_mask:0xf bank_mask:0xf
    v_add_f32_dpp v23, v75, v23 quad_perm:[3,3,3,3] row_mask:0xf bank_mask:0xf
    v_add_f32_dpp v24, v79, v24 quad_perm:[3,3,3,3] row_mask:0xf bank_mask:0xf
    v_add_f32_dpp v25, v83, v25 quad_perm:[3,3,3,3] row_mask:0xf bank_mask:0xf
    buffer_load_dwordx4 v[216:219], v2, s[8:11], s57 offen offset:1024 nt
    v_cvt_pk_bf16_f32 v26, v22, v23
    v_cvt_pk_bf16_f32 v27, v24, v25
    v_lshlrev_b32 v22, 16, v26
    v_and_b32 v23, s70, v26
    v_lshlrev_b32 v24, 16, v27
    v_and_b32 v25, s70, v27
    v_mul_f32 v22, s68, v22
    v_mul_f32 v23, s68, v23
    v_mul_f32 v24, s68, v24
    v_mul_f32 v25, s68, v25
    v_cvt_pk_bf16_f32 v34, v22, v23
    v_cvt_pk_bf16_f32 v35, v24, v25
    v_max3_f32 v20, v20, v22, v23
    v_max3_f32 v20, v20, v24, v25
    s_waitcnt vmcnt(26)
    v_mfma_f32_16x16x32_bf16 v[100:103], v[100:103], v[4:7], 0
    v_mfma_f32_16x16x32_bf16 v[104:107], v[104:107], v[4:7], 0
    v_mfma_f32_16x16x32_bf16 v[108:111], v[108:111], v[4:7], 0
    v_mfma_f32_16x16x32_bf16 v[112:115], v[112:115], v[4:7], 0
    v_mov_b32_dpp v22, v84 quad_perm:[0,0,0,0] row_mask:0xf bank_mask:0xf
    v_mov_b32_dpp v23, v88 quad_perm:[0,0,0,0] row_mask:0xf bank_mask:0xf
    v_mov_b32_dpp v24, v92 quad_perm:[0,0,0,0] row_mask:0xf bank_mask:0xf
    v_mov_b32_dpp v25, v96 quad_perm:[0,0,0,0] row_mask:0xf bank_mask:0xf
    v_add_f32_dpp v22, v85, v22 quad_perm:[1,1,1,1] row_mask:0xf bank_mask:0xf
    v_add_f32_dpp v23, v89, v23 quad_perm:[1,1,1,1] row_mask:0xf bank_mask:0xf
    v_add_f32_dpp v24, v93, v24 quad_perm:[1,1,1,1] row_mask:0xf bank_mask:0xf
    v_add_f32_dpp v25, v97, v25 quad_perm:[1,1,1,1] row_mask:0xf bank_mask:0xf
    v_add_f32_dpp v22, v86, v22 quad_perm:[2,2,2,2] row_mask:0xf bank_mask:0xf
    v_add_f32_dpp v23, v90, v23 quad_perm:[2,2,2,2] row_mask:0xf bank_mask:0xf
    v_add_f32_dpp v24, v94, v24 quad_perm:[2,2,2,2] row_mask:0xf bank_mask:0xf
    v_add_f32_dpp v25, v98, v25 quad_perm:[2,2,2,2] row_mask:0xf bank_mask:0xf
    v_add_f32_dpp v22, v87, v22 quad_perm:[3,3,3,3] row_mask:0xf bank_mask:0xf
    v_add_f32_dpp v23, v91, v23 quad_perm:[3,3,3,3] row_mask:0xf bank_mask:0xf
    v_add_f32_dpp v24, v95, v24 quad_perm:[3,3,3,3] row_mask:0xf bank_mask:0xf
    v_add_f32_dpp v25, v99, v25 quad_perm:[3,3,3,3] row_mask:0xf bank_mask:0xf
    buffer_load_dwordx4 v[220:223], v2, s[8:11], s57 offen offset:2048 nt
    v_cvt_pk_bf16_f32 v26, v22, v23
    v_cvt_pk_bf16_f32 v27, v24, v25
    v_lshlrev_b32 v22, 16, v26
    v_and_b32 v23, s70, v26
    v_lshlrev_b32 v24, 16, v27
    v_and_b32 v25, s70, v27
    v_mul_f32 v22, s68, v22
    v_mul_f32 v23, s68, v23
    v_mul_f32 v24, s68, v24
    v_mul_f32 v25, s68, v25
    v_cvt_pk_bf16_f32 v36, v22, v23
    v_cvt_pk_bf16_f32 v37, v24, v25
    v_max3_f32 v20, v20, v22, v23
    v_max3_f32 v20, v20, v24, v25
    s_waitcnt vmcnt(23)
    v_mfma_f32_16x16x32_bf16 v[116:119], v[116:119], v[4:7], 0
    v_mfma_f32_16x16x32_bf16 v[120:123], v[120:123], v[4:7], 0
    v_mfma_f32_16x16x32_bf16 v[124:127], v[124:127], v[4:7], 0
    v_mfma_f32_16x16x32_bf16 v[128:131], v[128:131], v[4:7], 0
    v_mov_b32_dpp v22, v100 quad_perm:[0,0,0,0] row_mask:0xf bank_mask:0xf
    v_mov_b32_dpp v23, v104 quad_perm:[0,0,0,0] row_mask:0xf bank_mask:0xf
    v_mov_b32_dpp v24, v108 quad_perm:[0,0,0,0] row_mask:0xf bank_mask:0xf
    v_mov_b32_dpp v25, v112 quad_perm:[0,0,0,0] row_mask:0xf bank_mask:0xf
    v_add_f32_dpp v22, v101, v22 quad_perm:[1,1,1,1] row_mask:0xf bank_mask:0xf
    v_add_f32_dpp v23, v105, v23 quad_perm:[1,1,1,1] row_mask:0xf bank_mask:0xf
    v_add_f32_dpp v24, v109, v24 quad_perm:[1,1,1,1] row_mask:0xf bank_mask:0xf
    v_add_f32_dpp v25, v113, v25 quad_perm:[1,1,1,1] row_mask:0xf bank_mask:0xf
    v_add_f32_dpp v22, v102, v22 quad_perm:[2,2,2,2] row_mask:0xf bank_mask:0xf
    v_add_f32_dpp v23, v106, v23 quad_perm:[2,2,2,2] row_mask:0xf bank_mask:0xf
    v_add_f32_dpp v24, v110, v24 quad_perm:[2,2,2,2] row_mask:0xf bank_mask:0xf
    v_add_f32_dpp v25, v114, v25 quad_perm:[2,2,2,2] row_mask:0xf bank_mask:0xf
    v_add_f32_dpp v22, v103, v22 quad_perm:[3,3,3,3] row_mask:0xf bank_mask:0xf
    v_add_f32_dpp v23, v107, v23 quad_perm:[3,3,3,3] row_mask:0xf bank_mask:0xf
    v_add_f32_dpp v24, v111, v24 quad_perm:[3,3,3,3] row_mask:0xf bank_mask:0xf
    v_add_f32_dpp v25, v115, v25 quad_perm:[3,3,3,3] row_mask:0xf bank_mask:0xf
    buffer_load_dwordx4 v[224:227], v2, s[8:11], s57 offen offset:3072 nt
    s_add_u32 s57, s57, 28672
    v_cvt_pk_bf16_f32 v26, v22, v23
    v_cvt_pk_bf16_f32 v27, v24, v25
    v_lshlrev_b32 v22, 16, v26
    v_and_b32 v23, s70, v26
    v_lshlrev_b32 v24, 16, v27
    v_and_b32 v25, s70, v27
    v_mul_f32 v22, s68, v22
    v_mul_f32 v23, s68, v23
    v_mul_f32 v24, s68, v24
    v_mul_f32 v25, s68, v25
    v_cvt_pk_bf16_f32 v38, v22, v23
    v_cvt_pk_bf16_f32 v39, v24, v25
    v_max3_f32 v20, v20, v22, v23
    v_max3_f32 v20, v20, v24, v25
    s_waitcnt vmcnt(20)
    v_mfma_f32_16x16x32_bf16 v[132:135], v[132:135], v[4:7], 0
    v_mfma_f32_16x16x32_bf16 v[136:139], v[136:139], v[4:7], 0
    v_mfma_f32_16x16x32_bf16 v[140:143], v[140:143], v[4:7], 0
    v_mfma_f32_16x16x32_bf16 v[144:147], v[144:147], v[4:7], 0
    v_mov_b32_dpp v22, v116 quad_perm:[0,0,0,0] row_mask:0xf bank_mask:0xf
    v_mov_b32_dpp v23, v120 quad_perm:[0,0,0,0] row_mask:0xf bank_mask:0xf
    v_mov_b32_dpp v24, v124 quad_perm:[0,0,0,0] row_mask:0xf bank_mask:0xf
    v_mov_b32_dpp v25, v128 quad_perm:[0,0,0,0] row_mask:0xf bank_mask:0xf
    v_add_f32_dpp v22, v117, v22 quad_perm:[1,1,1,1] row_mask:0xf bank_mask:0xf
    v_add_f32_dpp v23, v121, v23 quad_perm:[1,1,1,1] row_mask:0xf bank_mask:0xf
    v_add_f32_dpp v24, v125, v24 quad_perm:[1,1,1,1] row_mask:0xf bank_mask:0xf
    v_add_f32_dpp v25, v129, v25 quad_perm:[1,1,1,1] row_mask:0xf bank_mask:0xf
    v_add_f32_dpp v22, v118, v22 quad_perm:[2,2,2,2] row_mask:0xf bank_mask:0xf
    v_add_f32_dpp v23, v122, v23 quad_perm:[2,2,2,2] row_mask:0xf bank_mask:0xf
    v_add_f32_dpp v24, v126, v24 quad_perm:[2,2,2,2] row_mask:0xf bank_mask:0xf
    v_add_f32_dpp v25, v130, v25 quad_perm:[2,2,2,2] row_mask:0xf bank_mask:0xf
    v_add_f32_dpp v22, v119, v22 quad_perm:[3,3,3,3] row_mask:0xf bank_mask:0xf
    v_add_f32_dpp v23, v123, v23 quad_perm:[3,3,3,3] row_mask:0xf bank_mask:0xf
    v_add_f32_dpp v24, v127, v24 quad_perm:[3,3,3,3] row_mask:0xf bank_mask:0xf
    v_add_f32_dpp v25, v131, v25 quad_perm:[3,3,3,3] row_mask:0xf bank_mask:0xf
    buffer_load_dwordx4 v[228:231], v2, s[8:11], s57 offen offset:0 nt
    v_cvt_pk_bf16_f32 v26, v22, v23
    v_cvt_pk_bf16_f32 v27, v24, v25
    v_lshlrev_b32 v22, 16, v26
    v_and_b32 v23, s70, v26
    v_lshlrev_b32 v24, 16, v27
    v_and_b32 v25, s70, v27
    v_mul_f32 v22, s68, v22
    v_mul_f32 v23, s68, v23
    v_mul_f32 v24, s68, v24
    v_mul_f32 v25, s68, v25
    v_cvt_pk_bf16_f32 v40, v22, v23
    v_cvt_pk_bf16_f32 v41, v24, v25
    v_max3_f32 v20, v20, v22, v23
    v_max3_f32 v20, v20, v24, v25
    s_waitcnt vmcnt(17)
    v_mfma_f32_16x16x32_bf16 v[148:151], v[148:151], v[4:7], 0
    v_mfma_f32_16x16x32_bf16 v[152:155], v[152:155], v[4:7], 0
    v_mfma_f32_16x16x32_bf16 v[156:159], v[156:159], v[4:7], 0
    v_mfma_f32_16x16x32_bf16 v[160:163], v[160:163], v[4:7], 0
    v_mov_b32_dpp v22, v132 quad_perm:[0,0,0,0] row_mask:0xf bank_mask:0xf
    v_mov_b32_dpp v23, v136 quad_perm:[0,0,0,0] row_mask:0xf bank_mask:0xf
    v_mov_b32_dpp v24, v140 quad_perm:[0,0,0,0] row_mask:0xf bank_mask:0xf
    v_mov_b32_dpp v25, v144 quad_perm:[0,0,0,0] row_mask:0xf bank_mask:0xf
    v_add_f32_dpp v22, v133, v22 quad_perm:[1,1,1,1] row_mask:0xf bank_mask:0xf
    v_add_f32_dpp v23, v137, v23 quad_perm:[1,1,1,1] row_mask:0xf bank_mask:0xf
    v_add_f32_dpp v24, v141, v24 quad_perm:[1,1,1,1] row_mask:0xf bank_mask:0xf
    v_add_f32_dpp v25, v145, v25 quad_perm:[1,1,1,1] row_mask:0xf bank_mask:0xf
    v_add_f32_dpp v22, v134, v22 quad_perm:[2,2,2,2] row_mask:0xf bank_mask:0xf
    v_add_f32_dpp v23, v138, v23 quad_perm:[2,2,2,2] row_mask:0xf bank_mask:0xf
    v_add_f32_dpp v24, v142, v24 quad_perm:[2,2,2,2] row_mask:0xf bank_mask:0xf
    v_add_f32_dpp v25, v146, v25 quad_perm:[2,2,2,2] row_mask:0xf bank_mask:0xf
    v_add_f32_dpp v22, v135, v22 quad_perm:[3,3,3,3] row_mask:0xf bank_mask:0xf
    v_add_f32_dpp v23, v139, v23 quad_perm:[3,3,3,3] row_mask:0xf bank_mask:0xf
    v_add_f32_dpp v24, v143, v24 quad_perm:[3,3,3,3] row_mask:0xf bank_mask:0xf
    v_add_f32_dpp v25, v147, v25 quad_perm:[3,3,3,3] row_mask:0xf bank_mask:0xf
    buffer_load_dwordx4 v[232:235], v2, s[8:11], s57 offen offset:1024 nt
    v_cvt_pk_bf16_f32 v26, v22, v23
    v_cvt_pk_bf16_f32 v27, v24, v25
    v_lshlrev_b32 v22, 16, v26
    v_and_b32 v23, s70, v26
    v_lshlrev_b32 v24, 16, v27
    v_and_b32 v25, s70, v27
    v_mul_f32 v22, s68, v22
    v_mul_f32 v23, s68, v23
    v_mul_f32 v24, s68, v24
    v_mul_f32 v25, s68, v25
    v_cvt_pk_bf16_f32 v42, v22, v23
    v_cvt_pk_bf16_f32 v43, v24, v25
    v_max3_f32 v20, v20, v22, v23
    v_max3_f32 v20, v20, v24, v25
    s_waitcnt vmcnt(14)
    v_mfma_f32_16x16x32_bf16 v[164:167], v[164:167], v[4:7], 0
    v_mfma_f32_16x16x32_bf16 v[168:171], v[168:171], v[4:7], 0
    v_mfma_f32_16x16x32_bf16 v[172:175], v[172:175], v[4:7], 0
    v_mfma_f32_16x16x32_bf16 v[176:179], v[176:179], v[4:7], 0
    v_mov_b32_dpp v22, v148 quad_perm:[0,0,0,0] row_mask:0xf bank_mask:0xf
    v_mov_b32_dpp v23, v152 quad_perm:[0,0,0,0] row_mask:0xf bank_mask:0xf
    v_mov_b32_dpp v24, v156 quad_perm:[0,0,0,0] row_mask:0xf bank_mask:0xf
    v_mov_b32_dpp v25, v160 quad_perm:[0,0,0,0] row_mask:0xf bank_mask:0xf
    v_add_f32_dpp v22, v149, v22 quad_perm:[1,1,1,1] row_mask:0xf bank_mask:0xf
    v_add_f32_dpp v23, v153, v23 quad_perm:[1,1,1,1] row_mask:0xf bank_mask:0xf
    v_add_f32_dpp v24, v157, v24 quad_perm:[1,1,1,1] row_mask:0xf bank_mask:0xf
    v_add_f32_dpp v25, v161, v25 quad_perm:[1,1,1,1] row_mask:0xf bank_mask:0xf
    v_add_f32_dpp v22, v150, v22 quad_perm:[2,2,2,2] row_mask:0xf bank_mask:0xf
    v_add_f32_dpp v23, v154, v23 quad_perm:[2,2,2,2] row_mask:0xf bank_mask:0xf
    v_add_f32_dpp v24, v158, v24 quad_perm:[2,2,2,2] row_mask:0xf bank_mask:0xf
    v_add_f32_dpp v25, v162, v25 quad_perm:[2,2,2,2] row_mask:0xf bank_mask:0xf
    v_add_f32_dpp v22, v151, v22 quad_perm:[3,3,3,3] row_mask:0xf bank_mask:0xf
    v_add_f32_dpp v23, v155, v23 quad_perm:[3,3,3,3] row_mask:0xf bank_mask:0xf
    v_add_f32_dpp v24, v159, v24 quad_perm:[3,3,3,3] row_mask:0xf bank_mask:0xf
    v_add_f32_dpp v25, v163, v25 quad_perm:[3,3,3,3] row_mask:0xf bank_mask:0xf
    buffer_load_dwordx4 v[236:239], v2, s[8:11], s57 offen offset:2048 nt
    v_cvt_pk_bf16_f32 v26, v22, v23
    v_cvt_pk_bf16_f32 v27, v24, v25
    v_lshlrev_b32 v22, 16, v26
    v_and_b32 v23, s70, v26
    v_lshlrev_b32 v24, 16, v27
    v_and_b32 v25, s70, v27
    v_mul_f32 v22, s68, v22
    v_mul_f32 v23, s68, v23
    v_mul_f32 v24, s68, v24
    v_mul_f32 v25, s68, v25
    v_cvt_pk_bf16_f32 v44, v22, v23
    v_cvt_pk_bf16_f32 v45, v24, v25
    v_max3_f32 v20, v20, v22, v23
    v_max3_f32 v20, v20, v24, v25
    s_waitcnt vmcnt(11)
    v_mfma_f32_16x16x32_bf16 v[180:183], v[180:183], v[4:7], 0
    v_mfma_f32_16x16x32_bf16 v[184:187], v[184:187], v[4:7], 0
    v_mfma_f32_16x16x32_bf16 v[188:191], v[188:191], v[4:7], 0
    v_mfma_f32_16x16x32_bf16 v[192:195], v[192:195], v[4:7], 0
    v_mov_b32_dpp v22, v164 quad_perm:[0,0,0,0] row_mask:0xf bank_mask:0xf
    v_mov_b32_dpp v23, v168 quad_perm:[0,0,0,0] row_mask:0xf bank_mask:0xf
    v_mov_b32_dpp v24, v172 quad_perm:[0,0,0,0] row_mask:0xf bank_mask:0xf
    v_mov_b32_dpp v25, v176 quad_perm:[0,0,0,0] row_mask:0xf bank_mask:0xf
    v_add_f32_dpp v22, v165, v22 quad_perm:[1,1,1,1] row_mask:0xf bank_mask:0xf
    v_add_f32_dpp v23, v169, v23 quad_perm:[1,1,1,1] row_mask:0xf bank_mask:0xf
    v_add_f32_dpp v24, v173, v24 quad_perm:[1,1,1,1] row_mask:0xf bank_mask:0xf
    v_add_f32_dpp v25, v177, v25 quad_perm:[1,1,1,1] row_mask:0xf bank_mask:0xf
    v_add_f32_dpp v22, v166, v22 quad_perm:[2,2,2,2] row_mask:0xf bank_mask:0xf
    v_add_f32_dpp v23, v170, v23 quad_perm:[2,2,2,2] row_mask:0xf bank_mask:0xf
    v_add_f32_dpp v24, v174, v24 quad_perm:[2,2,2,2] row_mask:0xf bank_mask:0xf
    v_add_f32_dpp v25, v178, v25 quad_perm:[2,2,2,2] row_mask:0xf bank_mask:0xf
    v_add_f32_dpp v22, v167, v22 quad_perm:[3,3,3,3] row_mask:0xf bank_mask:0xf
    v_add_f32_dpp v23, v171, v23 quad_perm:[3,3,3,3] row_mask:0xf bank_mask:0xf
    v_add_f32_dpp v24, v175, v24 quad_perm:[3,3,3,3] row_mask:0xf bank_mask:0xf
    v_add_f32_dpp v25, v179, v25 quad_perm:[3,3,3,3] row_mask:0xf bank_mask:0xf
    buffer_load_dwordx4 v[240:243], v2, s[8:11], s57 offen offset:3072 nt
    s_add_u32 s57, s57, 28672
    v_cvt_pk_bf16_f32 v26, v22, v23
    v_cvt_pk_bf16_f32 v27, v24, v25
    v_lshlrev_b32 v22, 16, v26
    v_and_b32 v23, s70, v26
    v_lshlrev_b32 v24, 16, v27
    v_and_b32 v25, s70, v27
    v_mul_f32 v22, s68, v22
    v_mul_f32 v23, s68, v23
    v_mul_f32 v24, s68, v24
    v_mul_f32 v25, s68, v25
    v_cvt_pk_bf16_f32 v46, v22, v23
    v_cvt_pk_bf16_f32 v47, v24, v25
    v_max3_f32 v20, v20, v22, v23
    v_max3_f32 v20, v20, v24, v25
    v_mov_b32_dpp v22, v180 quad_perm:[0,0,0,0] row_mask:0xf bank_mask:0xf
    v_mov_b32_dpp v23, v184 quad_perm:[0,0,0,0] row_mask:0xf bank_mask:0xf
    v_mov_b32_dpp v24, v188 quad_perm:[0,0,0,0] row_mask:0xf bank_mask:0xf
    v_mov_b32_dpp v25, v192 quad_perm:[0,0,0,0] row_mask:0xf bank_mask:0xf
    v_add_f32_dpp v22, v181, v22 quad_perm:[1,1,1,1] row_mask:0xf bank_mask:0xf
    v_add_f32_dpp v23, v185, v23 quad_perm:[1,1,1,1] row_mask:0xf bank_mask:0xf
    v_add_f32_dpp v24, v189, v24 quad_perm:[1,1,1,1] row_mask:0xf bank_mask:0xf
    v_add_f32_dpp v25, v193, v25 quad_perm:[1,1,1,1] row_mask:0xf bank_mask:0xf
    v_add_f32_dpp v22, v182, v22 quad_perm:[2,2,2,2] row_mask:0xf bank_mask:0xf
    v_add_f32_dpp v23, v186, v23 quad_perm:[2,2,2,2] row_mask:0xf bank_mask:0xf
    v_add_f32_dpp v24, v190, v24 quad_perm:[2,2,2,2] row_mask:0xf bank_mask:0xf
    v_add_f32_dpp v25, v194, v25 quad_perm:[2,2,2,2] row_mask:0xf bank_mask:0xf
    v_add_f32_dpp v22, v183, v22 quad_perm:[3,3,3,3] row_mask:0xf bank_mask:0xf
    v_add_f32_dpp v23, v187, v23 quad_perm:[3,3,3,3] row_mask:0xf bank_mask:0xf
    v_add_f32_dpp v24, v191, v24 quad_perm:[3,3,3,3] row_mask:0xf bank_mask:0xf
    v_add_f32_dpp v25, v195, v25 quad_perm:[3,3,3,3] row_mask:0xf bank_mask:0xf
    v_cvt_pk_bf16_f32 v26, v22, v23
    v_cvt_pk_bf16_f32 v27, v24, v25
    v_lshlrev_b32 v22, 16, v26
    v_and_b32 v23, s70, v26
    v_lshlrev_b32 v24, 16, v27
    v_and_b32 v25, s70, v27
    v_mul_f32 v22, s68, v22
    v_mul_f32 v23, s68, v23
    v_mul_f32 v24, s68, v24
    v_mul_f32 v25, s68, v25
    v_cvt_pk_bf16_f32 v48, v22, v23
    v_cvt_pk_bf16_f32 v49, v24, v25
    v_max3_f32 v20, v20, v22, v23
    v_max3_f32 v20, v20, v24, v25
    v_mov_b32 v22, v20
    s_nop 1
    v_permlane16_swap_b32 v20, v22
    s_nop 1
    v_max_f32 v20, v20, v22
    v_mov_b32 v22, v20
    s_nop 1
    v_permlane32_swap_b32 v20, v22
    s_nop 1
    v_max_f32 v20, v20, v22
    v_cvt_pk_bf16_f32 v20, v20, v20
    v_and_b32 v20, s70, v20
    v_lshlrev_b32 v22, 16, v32
    v_and_b32 v23, s70, v32
    v_sub_f32 v22, v22, v20
    v_sub_f32 v23, v23, v20
    v_mul_f32 v22, s69, v22
    v_mul_f32 v23, s69, v23
    v_exp_f32 v22, v22
    v_exp_f32 v23, v23
    s_nop 0
    v_add_f32 v21, v21, v22
    v_cvt_pk_bf16_f32 v32, v22, v23
    v_add_f32 v21, v21, v23
    v_lshlrev_b32 v24, 16, v33
    v_and_b32 v25, s70, v33
    v_sub_f32 v24, v24, v20
    v_sub_f32 v25, v25, v20
    v_mul_f32 v24, s69, v24
    v_mul_f32 v25, s69, v25
    v_exp_f32 v24, v24
    v_exp_f32 v25, v25
    s_nop 0
    v_add_f32 v21, v21, v24
    v_cvt_pk_bf16_f32 v33, v24, v25
    v_add_f32 v21, v21, v25
    v_lshlrev_b32 v22, 16, v34
    v_and_b32 v23, s70, v34
    v_sub_f32 v22, v22, v20
    v_sub_f32 v23, v23, v20
    v_mul_f32 v22, s69, v22
    v_mul_f32 v23, s69, v23
    v_exp_f32 v22, v22
    v_exp_f32 v23, v23
    s_nop 0
    v_add_f32 v21, v21, v22
    v_cvt_pk_bf16_f32 v34, v22, v23
    v_add_f32 v21, v21, v23
    v_lshlrev_b32 v24, 16, v35
    v_and_b32 v25, s70, v35
    v_sub_f32 v24, v24, v20
    v_sub_f32 v25, v25, v20
    v_mul_f32 v24, s69, v24
    v_mul_f32 v25, s69, v25
    v_exp_f32 v24, v24
    v_exp_f32 v25, v25
    s_nop 0
    v_add_f32 v21, v21, v24
    v_cvt_pk_bf16_f32 v35, v24, v25
    v_add_f32 v21, v21, v25
    v_lshlrev_b32 v22, 16, v36
    v_and_b32 v23, s70, v36
    v_sub_f32 v22, v22, v20
    v_sub_f32 v23, v23, v20
    v_mul_f32 v22, s69, v22
    v_mul_f32 v23, s69, v23
    v_exp_f32 v22, v22
    v_exp_f32 v23, v23
    s_nop 0
    v_add_f32 v21, v21, v22
    v_cvt_pk_bf16_f32 v36, v22, v23
    v_add_f32 v21, v21, v23
    v_lshlrev_b32 v24, 16, v37
    v_and_b32 v25, s70, v37
    v_sub_f32 v24, v24, v20
    v_sub_f32 v25, v25, v20
    v_mul_f32 v24, s69, v24
    v_mul_f32 v25, s69, v25
    v_exp_f32 v24, v24
    v_exp_f32 v25, v25
    s_nop 0
    v_add_f32 v21, v21, v24
    v_cvt_pk_bf16_f32 v37, v24, v25
    v_add_f32 v21, v21, v25
    v_lshlrev_b32 v22, 16, v38
    v_and_b32 v23, s70, v38
    v_sub_f32 v22, v22, v20
    v_sub_f32 v23, v23, v20
    v_mul_f32 v22, s69, v22
    v_mul_f32 v23, s69, v23
    v_exp_f32 v22, v22
    v_exp_f32 v23, v23
    s_nop 0
    v_add_f32 v21, v21, v22
    v_cvt_pk_bf16_f32 v38, v22, v23
    v_add_f32 v21, v21, v23
    v_lshlrev_b32 v24, 16, v39
    v_and_b32 v25, s70, v39
    v_sub_f32 v24, v24, v20
    v_sub_f32 v25, v25, v20
    v_mul_f32 v24, s69, v24
    v_mul_f32 v25, s69, v25
    v_exp_f32 v24, v24
    v_exp_f32 v25, v25
    s_nop 0
    v_add_f32 v21, v21, v24
    v_cvt_pk_bf16_f32 v39, v24, v25
    v_add_f32 v21, v21, v25
    v_lshlrev_b32 v22, 16, v40
    v_and_b32 v23, s70, v40
    v_sub_f32 v22, v22, v20
    v_sub_f32 v23, v23, v20
    v_mul_f32 v22, s69, v22
    v_mul_f32 v23, s69, v23
    v_exp_f32 v22, v22
    v_exp_f32 v23, v23
    s_nop 0
    v_add_f32 v21, v21, v22
    v_cvt_pk_bf16_f32 v40, v22, v23
    v_add_f32 v21, v21, v23
    v_lshlrev_b32 v24, 16, v41
    v_and_b32 v25, s70, v41
    v_sub_f32 v24, v24, v20
    v_sub_f32 v25, v25, v20
    v_mul_f32 v24, s69, v24
    v_mul_f32 v25, s69, v25
    v_exp_f32 v24, v24
    v_exp_f32 v25, v25
    s_nop 0
    v_add_f32 v21, v21, v24
    v_cvt_pk_bf16_f32 v41, v24, v25
    v_add_f32 v21, v21, v25
    v_lshlrev_b32 v22, 16, v42
    v_and_b32 v23, s70, v42
    v_sub_f32 v22, v22, v20
    v_sub_f32 v23, v23, v20
    v_mul_f32 v22, s69, v22
    v_mul_f32 v23, s69, v23
    v_exp_f32 v22, v22
    v_exp_f32 v23, v23
    s_nop 0
    v_add_f32 v21, v21, v22
    v_cvt_pk_bf16_f32 v42, v22, v23
    v_add_f32 v21, v21, v23
    v_lshlrev_b32 v24, 16, v43
    v_and_b32 v25, s70, v43
    v_sub_f32 v24, v24, v20
    v_sub_f32 v25, v25, v20
    v_mul_f32 v24, s69, v24
    v_mul_f32 v25, s69, v25
    v_exp_f32 v24, v24
    v_exp_f32 v25, v25
    s_nop 0
    v_add_f32 v21, v21, v24
    v_cvt_pk_bf16_f32 v43, v24, v25
    v_add_f32 v21, v21, v25
    v_lshlrev_b32 v22, 16, v44
    v_and_b32 v23, s70, v44
    v_sub_f32 v22, v22, v20
    v_sub_f32 v23, v23, v20
    v_mul_f32 v22, s69, v22
    v_mul_f32 v23, s69, v23
    v_exp_f32 v22, v22
    v_exp_f32 v23, v23
    s_nop 0
    v_add_f32 v21, v21, v22
    v_cvt_pk_bf16_f32 v44, v22, v23
    v_add_f32 v21, v21, v23
    v_lshlrev_b32 v24, 16, v45
    v_and_b32 v25, s70, v45
    v_sub_f32 v24, v24, v20
    v_sub_f32 v25, v25, v20
    v_mul_f32 v24, s69, v24
    v_mul_f32 v25, s69, v25
    v_exp_f32 v24, v24
    v_exp_f32 v25, v25
    s_nop 0
    v_add_f32 v21, v21, v24
    v_cvt_pk_bf16_f32 v45, v24, v25
    v_add_f32 v21, v21, v25
    v_lshlrev_b32 v22, 16, v46
    v_and_b32 v23, s70, v46
    v_sub_f32 v22, v22, v20
    v_sub_f32 v23, v23, v20
    v_mul_f32 v22, s69, v22
    v_mul_f32 v23, s69, v23
    v_exp_f32 v22, v22
    v_exp_f32 v23, v23
    s_nop 0
    v_add_f32 v21, v21, v22
    v_cvt_pk_bf16_f32 v46, v22, v23
    v_add_f32 v21, v21, v23
    v_lshlrev_b32 v24, 16, v47
    v_and_b32 v25, s70, v47
    v_sub_f32 v24, v24, v20
    v_sub_f32 v25, v25, v20
    v_mul_f32 v24, s69, v24
    v_mul_f32 v25, s69, v25
    v_exp_f32 v24, v24
    v_exp_f32 v25, v25
    s_nop 0
    v_add_f32 v21, v21, v24
    v_cvt_pk_bf16_f32 v47, v24, v25
    v_add_f32 v21, v21, v25
    v_lshlrev_b32 v22, 16, v48
    v_and_b32 v23, s70, v48
    v_sub_f32 v22, v22, v20
    v_sub_f32 v23, v23, v20
    v_mul_f32 v22, s69, v22
    v_mul_f32 v23, s69, v23
    v_exp_f32 v22, v22
    v_exp_f32 v23, v23
    s_nop 0
    v_add_f32 v21, v21, v22
    v_cvt_pk_bf16_f32 v48, v22, v23
    v_add_f32 v21, v21, v23
    v_lshlrev_b32 v24, 16, v49
    v_and_b32 v25, s70, v49
    v_sub_f32 v24, v24, v20
    v_sub_f32 v25, v25, v20
    v_mul_f32 v24, s69, v24
    v_mul_f32 v25, s69, v25
    v_exp_f32 v24, v24
    v_exp_f32 v25, v25
    s_nop 0
    v_add_f32 v21, v21, v24
    v_cvt_pk_bf16_f32 v49, v24, v25
    v_add_f32 v21, v21, v25
    v_mov_b32 v22, v21
    s_nop 1
    v_permlane16_swap_b32 v21, v22
    s_nop 1
    v_add_f32 v21, v21, v22
    v_mov_b32 v22, v21
    s_nop 1
    v_permlane32_swap_b32 v21, v22
    s_nop 1
    v_add_f32 v21, v21, v22
    v_bfe_u32 v3, v0, 2, 2
    v_lshlrev_b32 v3, 6, v3
    s_lshl_b32 s66, s3, 3
    v_add_u32 v3, s66, v3
    ds_write_b64 v3, v[20:21] offset:256
    v_mov_b32 v3, 0
    v_mov_b32 v29, 1
    s_waitcnt lgkmcnt(0)
    s_mov_b64 exec, 1
    ds_add_u32 v3, v29 offset:4
    s_mov_b64 exec, -1
    s_mov_b32 s44, s24
    s_mov_b32 s45, s25
    s_mov_b32 s46, 0x400000
    s_mov_b32 s60, s32
    s_mov_b32 s61, s33
    s_mov_b32 s62, 1835008
    s_mov_b32 s63, 0x20000
    s_lshl_b32 s66, s49, 2
    s_add_u32 s66, s66, s3
    s_lshl_b32 s67, s48, 7
    s_lshl_b32 s98, s66, 15
    s_add_u32 s98, s98, s67
    s_lshl_b32 s58, s66, 14
    s_add_u32 s58, s58, s67
    s_add_u32 s59, s58, 7168
    s_lshl_b32 s64, s3, 12
    s_add_u32 s64, s64, 43008
    s_lshl_b32 s66, s3, 11
    s_add_u32 m0, s66, 34816
    v_lshrrev_b32 v50, 3, v0
    v_and_b32 v28, 7, v0
    v_and_b32 v51, 2, v50
    v_xor_b32 v28, v28, v51
    v_lshlrev_b32 v28, 4, v28
    v_lshl_add_u32 v28, v50, 10, v28
    v_xor_b32 v30, 64, v28
    s_add_u32 s99, s98, 7168
    s_add_u32 s100, s98, 14336
    s_add_u32 s101, s98, 21504
    v_perm_b32 v22, v32, v32, v8
    v_perm_b32 v23, v32, v32, v9
    v_perm_b32 v24, v32, v32, v10
    v_perm_b32 v25, v32, v32, v11
    s_waitcnt vmcnt(3)
    buffer_load_dwordx4 v[244:247], v2, s[8:11], s57 offen offset:0 nt
    v_mfma_f32_16x16x16_bf16 v[12:15], v[22:23], v[196:197], v[12:15]
    v_mfma_f32_16x16x16_bf16 v[16:19], v[22:23], v[198:199], v[16:19]
    v_perm_b32 v26, v33, v33, v8
    v_perm_b32 v27, v33, v33, v9
    v_mfma_f32_16x16x16_bf16 v[12:15], v[24:25], v[200:201], v[12:15]
    v_mfma_f32_16x16x16_bf16 v[16:19], v[24:25], v[202:203], v[16:19]
    v_perm_b32 v22, v33, v33, v10
    v_perm_b32 v23, v33, v33, v11
    v_mfma_f32_16x16x16_bf16 v[12:15], v[26:27], v[204:205], v[12:15]
    v_mfma_f32_16x16x16_bf16 v[16:19], v[26:27], v[206:207], v[16:19]
    v_perm_b32 v24, v34, v34, v8
    v_perm_b32 v25, v34, v34, v9
    s_waitcnt vmcnt(3)
    buffer_load_dwordx4 v[248:251], v2, s[8:11], s57 offen offset:1024 nt
    v_mfma_f32_16x16x16_bf16 v[12:15], v[22:23], v[208:209], v[12:15]
    v_mfma_f32_16x16x16_bf16 v[16:19], v[22:23], v[210:211], v[16:19]
    v_perm_b32 v26, v34, v34, v10
    v_perm_b32 v27, v34, v34, v11
    v_mfma_f32_16x16x16_bf16 v[12:15], v[24:25], v[212:213], v[12:15]
    v_mfma_f32_16x16x16_bf16 v[16:19], v[24:25], v[214:215], v[16:19]
    v_perm_b32 v22, v35, v35, v8
    v_perm_b32 v23, v35, v35, v9
    v_mfma_f32_16x16x16_bf16 v[12:15], v[26:27], v[216:217], v[12:15]
    v_mfma_f32_16x16x16_bf16 v[16:19], v[26:27], v[218:219], v[16:19]
    v_perm_b32 v24, v35, v35, v10
    v_perm_b32 v25, v35, v35, v11
    s_waitcnt vmcnt(3)
    buffer_load_dwordx4 v[252:255], v2, s[8:11], s57 offen offset:2048 nt
    v_mfma_f32_16x16x16_bf16 v[12:15], v[22:23], v[220:221], v[12:15]
    v_mfma_f32_16x16x16_bf16 v[16:19], v[22:23], v[222:223], v[16:19]
    v_perm_b32 v26, v36, v36, v8
    v_perm_b32 v27, v36, v36, v9
    v_mfma_f32_16x16x16_bf16 v[12:15], v[24:25], v[224:225], v[12:15]
    v_mfma_f32_16x16x16_bf16 v[16:19], v[24:25], v[226:227], v[16:19]
    v_perm_b32 v22, v36, v36, v10
    v_perm_b32 v23, v36, v36, v11
    v_mfma_f32_16x16x16_bf16 v[12:15], v[26:27], v[228:229], v[12:15]
    v_mfma_f32_16x16x16_bf16 v[16:19], v[26:27], v[230:231], v[16:19]
    v_perm_b32 v24, v37, v37, v8
    v_perm_b32 v25, v37, v37, v9
    s_waitcnt vmcnt(3)
    buffer_load_dwordx4 v[52:55], v2, s[8:11], s57 offen offset:3072 nt
    s_add_u32 s57, s57, 28672
    v_mfma_f32_16x16x16_bf16 v[12:15], v[22:23], v[232:233], v[12:15]
    v_mfma_f32_16x16x16_bf16 v[16:19], v[22:23], v[234:235], v[16:19]
    v_perm_b32 v26, v37, v37, v10
    v_perm_b32 v27, v37, v37, v11
    v_mfma_f32_16x16x16_bf16 v[12:15], v[24:25], v[236:237], v[12:15]
    v_mfma_f32_16x16x16_bf16 v[16:19], v[24:25], v[238:239], v[16:19]
    v_perm_b32 v22, v38, v38, v8
    v_perm_b32 v23, v38, v38, v9
    v_mfma_f32_16x16x16_bf16 v[12:15], v[26:27], v[240:241], v[12:15]
    v_mfma_f32_16x16x16_bf16 v[16:19], v[26:27], v[242:243], v[16:19]
    v_perm_b32 v24, v38, v38, v10
    v_perm_b32 v25, v38, v38, v11
    s_waitcnt vmcnt(3)
    buffer_load_dwordx4 v[56:59], v2, s[8:11], s57 offen offset:0 nt
    v_mfma_f32_16x16x16_bf16 v[12:15], v[22:23], v[244:245], v[12:15]
    v_mfma_f32_16x16x16_bf16 v[16:19], v[22:23], v[246:247], v[16:19]
    v_perm_b32 v26, v39, v39, v8
    v_perm_b32 v27, v39, v39, v9
    s_waitcnt vmcnt(3)
    buffer_load_dwordx4 v[60:63], v2, s[8:11], s57 offen offset:1024 nt
    v_mfma_f32_16x16x16_bf16 v[12:15], v[24:25], v[248:249], v[12:15]
    v_mfma_f32_16x16x16_bf16 v[16:19], v[24:25], v[250:251], v[16:19]
    v_perm_b32 v22, v39, v39, v10
    v_perm_b32 v23, v39, v39, v11
    s_waitcnt vmcnt(3)
    buffer_load_dwordx4 v[64:67], v2, s[8:11], s57 offen offset:2048 nt
    v_mfma_f32_16x16x16_bf16 v[12:15], v[26:27], v[252:253], v[12:15]
    v_mfma_f32_16x16x16_bf16 v[16:19], v[26:27], v[254:255], v[16:19]
    v_perm_b32 v24, v40, v40, v8
    v_perm_b32 v25, v40, v40, v9
    s_waitcnt vmcnt(3)
    buffer_load_dwordx4 v[68:71], v2, s[8:11], s57 offen offset:3072 nt
    s_add_u32 s57, s57, 28672
    v_mfma_f32_16x16x16_bf16 v[12:15], v[22:23], v[52:53], v[12:15]
    v_mfma_f32_16x16x16_bf16 v[16:19], v[22:23], v[54:55], v[16:19]
    v_perm_b32 v26, v40, v40, v10
    v_perm_b32 v27, v40, v40, v11
    s_waitcnt vmcnt(3)
    buffer_load_dwordx4 v[72:75], v2, s[8:11], s57 offen offset:0 nt
    v_mfma_f32_16x16x16_bf16 v[12:15], v[24:25], v[56:57], v[12:15]
    v_mfma_f32_16x16x16_bf16 v[16:19], v[24:25], v[58:59], v[16:19]
    v_perm_b32 v22, v41, v41, v8
    v_perm_b32 v23, v41, v41, v9
    s_waitcnt vmcnt(3)
    buffer_load_dwordx4 v[76:79], v2, s[8:11], s57 offen offset:1024 nt
    v_mfma_f32_16x16x16_bf16 v[12:15], v[26:27], v[60:61], v[12:15]
    v_mfma_f32_16x16x16_bf16 v[16:19], v[26:27], v[62:63], v[16:19]
    v_perm_b32 v24, v41, v41, v10
    v_perm_b32 v25, v41, v41, v11
    s_waitcnt vmcnt(3)
    buffer_load_dwordx4 v[80:83], v2, s[8:11], s57 offen offset:2048 nt
    v_mfma_f32_16x16x16_bf16 v[12:15], v[22:23], v[64:65], v[12:15]
    v_mfma_f32_16x16x16_bf16 v[16:19], v[22:23], v[66:67], v[16:19]
    v_perm_b32 v26, v42, v42, v8
    v_perm_b32 v27, v42, v42, v9
    s_waitcnt vmcnt(3)
    buffer_load_dwordx4 v[84:87], v2, s[8:11], s57 offen offset:3072 nt
    s_add_u32 s57, s57, 28672
    v_mfma_f32_16x16x16_bf16 v[12:15], v[24:25], v[68:69], v[12:15]
    v_mfma_f32_16x16x16_bf16 v[16:19], v[24:25], v[70:71], v[16:19]
    v_perm_b32 v22, v42, v42, v10
    v_perm_b32 v23, v42, v42, v11
    s_waitcnt vmcnt(3)
    buffer_load_dwordx4 v[88:91], v2, s[8:11], s57 offen offset:0 nt
    v_mfma_f32_16x16x16_bf16 v[12:15], v[26:27], v[72:73], v[12:15]
    v_mfma_f32_16x16x16_bf16 v[16:19], v[26:27], v[74:75], v[16:19]
    v_perm_b32 v24, v43, v43, v8
    v_perm_b32 v25, v43, v43, v9
    s_waitcnt vmcnt(3)
    buffer_load_dwordx4 v[92:95], v2, s[8:11], s57 offen offset:1024 nt
    v_mfma_f32_16x16x16_bf16 v[12:15], v[22:23], v[76:77], v[12:15]
    v_mfma_f32_16x16x16_bf16 v[16:19], v[22:23], v[78:79], v[16:19]
    v_perm_b32 v26, v43, v43, v10
    v_perm_b32 v27, v43, v43, v11
    s_waitcnt vmcnt(3)
    buffer_load_dwordx4 v[96:99], v2, s[8:11], s57 offen offset:2048 nt
    v_mfma_f32_16x16x16_bf16 v[12:15], v[24:25], v[80:81], v[12:15]
    v_mfma_f32_16x16x16_bf16 v[16:19], v[24:25], v[82:83], v[16:19]
    v_perm_b32 v22, v44, v44, v8
    v_perm_b32 v23, v44, v44, v9
    s_waitcnt vmcnt(3)
    buffer_load_dwordx4 v[100:103], v2, s[8:11], s57 offen offset:3072 nt
    s_add_u32 s57, s57, 28672
    v_mfma_f32_16x16x16_bf16 v[12:15], v[26:27], v[84:85], v[12:15]
    v_mfma_f32_16x16x16_bf16 v[16:19], v[26:27], v[86:87], v[16:19]
    v_perm_b32 v24, v44, v44, v10
    v_perm_b32 v25, v44, v44, v11
    s_waitcnt vmcnt(7)
    buffer_load_dwordx4 v[104:107], v2, s[8:11], s57 offen offset:0 nt
    s_waitcnt vmcnt(7)
    buffer_load_dwordx4 v[108:111], v2, s[8:11], s57 offen offset:1024 nt
    s_waitcnt vmcnt(7)
    buffer_load_dwordx4 v[112:115], v2, s[8:11], s57 offen offset:2048 nt
    s_waitcnt vmcnt(7)
    buffer_load_dwordx4 v[116:119], v2, s[8:11], s57 offen offset:3072 nt
    s_add_u32 s57, s57, 28672
    ds_write_b32 v3, v29 offset:8
    s_waitcnt vmcnt(7)
    buffer_load_dwordx4 v[120:123], v2, s[8:11], s57 offen offset:0 nt
    v_mfma_f32_16x16x16_bf16 v[12:15], v[22:23], v[88:89], v[12:15]
    v_mfma_f32_16x16x16_bf16 v[16:19], v[22:23], v[90:91], v[16:19]
    v_perm_b32 v26, v45, v45, v8
    v_perm_b32 v27, v45, v45, v9
    s_waitcnt vmcnt(7)
    buffer_load_dwordx4 v[124:127], v2, s[8:11], s57 offen offset:1024 nt
    v_mfma_f32_16x16x16_bf16 v[12:15], v[24:25], v[92:93], v[12:15]
    v_mfma_f32_16x16x16_bf16 v[16:19], v[24:25], v[94:95], v[16:19]
    v_perm_b32 v22, v45, v45, v10
    v_perm_b32 v23, v45, v45, v11
    s_waitcnt vmcnt(7)
    buffer_load_dwordx4 v[128:131], v2, s[8:11], s57 offen offset:2048 nt
    v_mfma_f32_16x16x16_bf16 v[12:15], v[26:27], v[96:97], v[12:15]
    v_mfma_f32_16x16x16_bf16 v[16:19], v[26:27], v[98:99], v[16:19]
    v_perm_b32 v24, v46, v46, v8
    v_perm_b32 v25, v46, v46, v9
    s_waitcnt vmcnt(7)
    buffer_load_dwordx4 v[132:135], v2, s[8:11], s57 offen offset:3072 nt
    v_mfma_f32_16x16x16_bf16 v[12:15], v[22:23], v[100:101], v[12:15]
    v_mfma_f32_16x16x16_bf16 v[16:19], v[22:23], v[102:103], v[16:19]
    v_perm_b32 v26, v46, v46, v10
    v_perm_b32 v27, v46, v46, v11
    s_mov_b32 s92, 0
    v_mov_b32 v31, 0
    s_lshl_b32 s66, s3, 11
    v_add_u32 v3, s66, v2
    s_waitcnt vmcnt(7)
    v_mfma_f32_16x16x16_bf16 v[12:15], v[24:25], v[104:105], v[12:15]
    v_mfma_f32_16x16x16_bf16 v[16:19], v[24:25], v[106:107], v[16:19]
    v_perm_b32 v22, v47, v47, v8
    v_perm_b32 v23, v47, v47, v9
    s_waitcnt vmcnt(6)
    v_mfma_f32_16x16x16_bf16 v[12:15], v[26:27], v[108:109], v[12:15]
    v_mfma_f32_16x16x16_bf16 v[16:19], v[26:27], v[110:111], v[16:19]
    v_perm_b32 v24, v47, v47, v10
    v_perm_b32 v25, v47, v47, v11
    s_waitcnt vmcnt(5)
    v_mfma_f32_16x16x16_bf16 v[12:15], v[22:23], v[112:113], v[12:15]
    v_mfma_f32_16x16x16_bf16 v[16:19], v[22:23], v[114:115], v[16:19]
    v_perm_b32 v26, v48, v48, v8
    v_perm_b32 v27, v48, v48, v9
    s_waitcnt vmcnt(4)
    v_mfma_f32_16x16x16_bf16 v[12:15], v[24:25], v[116:117], v[12:15]
    v_mfma_f32_16x16x16_bf16 v[16:19], v[24:25], v[118:119], v[16:19]
    v_perm_b32 v22, v48, v48, v10
    v_perm_b32 v23, v48, v48, v11
    s_waitcnt vmcnt(3)
    v_mfma_f32_16x16x16_bf16 v[12:15], v[26:27], v[120:121], v[12:15]
    v_mfma_f32_16x16x16_bf16 v[16:19], v[26:27], v[122:123], v[16:19]
    v_perm_b32 v24, v49, v49, v8
    v_perm_b32 v25, v49, v49, v9
    s_waitcnt vmcnt(2)
    v_mfma_f32_16x16x16_bf16 v[12:15], v[22:23], v[124:125], v[12:15]
    v_mfma_f32_16x16x16_bf16 v[16:19], v[22:23], v[126:127], v[16:19]
    v_perm_b32 v26, v49, v49, v10
    v_perm_b32 v27, v49, v49, v11
    s_waitcnt vmcnt(1)
    v_mfma_f32_16x16x16_bf16 v[12:15], v[24:25], v[128:129], v[12:15]
    v_mfma_f32_16x16x16_bf16 v[16:19], v[24:25], v[130:131], v[16:19]
    s_waitcnt vmcnt(0)
    v_mfma_f32_16x16x16_bf16 v[12:15], v[26:27], v[132:133], v[12:15]
    v_mfma_f32_16x16x16_bf16 v[16:19], v[26:27], v[134:135], v[16:19]
    ds_read_b32 v31, v31 offset:12
    s_nop 5
    ds_write_b128 v3, v[12:15] offset:2048
    ds_write_b128 v3, v[16:19] offset:3072
    s_cmp_ge_u32 s3, 4
    s_waitcnt lgkmcnt(0)
    s_cbranch_scc1 L_aux
    v_readfirstlane_b32 s92, v31
    s_nop 0
    s_cmp_eq_u32 s92, 0
    s_cbranch_scc1 L_notlate
    buffer_load_dwordx4 v28, s[60:63], s58 offen offset:0 nt lds
    buffer_load_dwordx4 v30, s[60:63], s59 offen offset:1024 nt lds
    s_mov_b32 m0, s64
    s_nop 0
    buffer_load_dwordx4 v28, s[44:47], s98 offen offset:0 nt lds
    buffer_load_dwordx4 v30, s[44:47], s99 offen offset:1024 nt lds
    buffer_load_dwordx4 v28, s[44:47], s100 offen offset:2048 nt lds
    buffer_load_dwordx4 v30, s[44:47], s101 offen offset:3072 nt lds
L_notlate:
    s_barrier
    ds_read_b128 v[104:107], v2 offset:26624
    ds_read_b128 v[108:111], v2 offset:27648
    s_barrier
    s_cmp_lg_u32 s92, 0
    s_cbranch_scc1 L_pc1
    buffer_load_dwordx4 v28, s[60:63], s58 offen offset:0 nt lds
    buffer_load_dwordx4 v30, s[60:63], s59 offen offset:1024 nt lds
    s_mov_b32 m0, s64
    s_nop 0
    buffer_load_dwordx4 v28, s[44:47], s98 offen offset:0 nt lds
    buffer_load_dwordx4 v30, s[44:47], s99 offen offset:1024 nt lds
    buffer_load_dwordx4 v28, s[44:47], s100 offen offset:2048 nt lds
    buffer_load_dwordx4 v30, s[44:47], s101 offen offset:3072 nt lds
L_pc1:
    v_lshrrev_b32 v3, 4, v0
    v_bfe_u32 v31, v0, 2, 2
    v_lshl_add_u32 v3, v3, 3, v31
    v_lshlrev_b32 v3, 7, v3
    v_and_b32 v31, 3, v0
    v_lshl_add_u32 v3, v31, 3, v3
    v_bfe_u32 v51, v0, 3, 2
    v_xor_b32 v51, s3, v51
    v_lshl_add_u32 v51, v51, 5, v3
    v_lshrrev_b32 v48, 3, v0
    v_and_b32 v31, 3, v0
    v_lshlrev_b32 v21, 6, v31
    v_lshl_add_u32 v21, v48, 2, v21
    v_and_b32 v31, 4, v0
    v_lshl_add_u32 v21, v31, 3, v21
    v_mul_u32_u24 v20, 344064, v48
    v_and_b32 v31, 7, v0
    v_lshl_add_u32 v48, v31, 4, v20
    s_mul_i32 s88, s3, 86016
    s_lshl_b32 s89, s48, 7
    s_add_u32 s90, s88, s89
    s_add_u32 s90, s90, 46080
    s_lshl_b32 s89, s48, 12
    s_add_u32 s88, s88, s89
    s_lshl_b32 s89, s49, 7
    s_add_u32 s88, s88, s89
    s_getreg_b32 s91, hwreg(HW_REG_XCC_ID)
    s_lshl_b32 s89, s3, 10
    v_add_u32 v49, s89, v2
    v_and_b32 v50, 15, v0
    v_lshlrev_b32 v50, 7, v50
    v_lshrrev_b32 v31, 4, v0
    v_lshl_add_u32 v50, v31, 4, v50
    s_mul_i32 s94, s49, 86016
    s_lshr_b32 s67, s3, 1
    s_lshl_b32 s67, s67, 11
    s_add_u32 s94, s94, s67
    s_and_b32 s67, s3, 1
    s_lshl_b32 s67, s67, 6
    s_add_u32 s94, s94, s67
    s_add_u32 s94, s94, 32768
    s_add_u32 s95, s94, 4096
    buffer_load_dword v20, v20, s[12:15], s90 offen sc1
    s_mov_b32 s65, 0
    s_mov_b64 vcc, -1
L_h1:
    s_mov_b64 exec, vcc
    buffer_load_dwordx4 v[88:91], v50, s[12:15], s94 offen sc1
    buffer_load_dwordx4 v[92:95], v50, s[12:15], s95 offen sc1
    s_add_u32 s65, s65, 1
    s_cmp_gt_u32 s65, 200000
    s_waitcnt vmcnt(0)
    s_cbranch_scc1 L_h1go
    v_max3_u32 v22, v88, v89, v90
    v_max3_u32 v23, v92, v93, v94
    v_max3_u32 v22, v22, v91, v95
    v_max_u32 v22, v22, v23
    v_cmp_eq_u32 vcc, -1, v22
    s_cbranch_vccnz L_h1
L_h1go:
    s_mov_b64 exec, -1
    ds_write_b128 v49, v[88:91] offset:18432
    ds_write_b128 v49, v[92:95] offset:22528
    v_cmp_eq_u32 s[96:97], s91, v20
    s_waitcnt lgkmcnt(0)
    s_barrier
    ds_read_b64_tr_b16 v[96:97], v51 offset:34816
    ds_read_b64_tr_b16 v[98:99], v51 offset:35328
    ds_read_b64_tr_b16 v[100:101], v51 offset:38912
    ds_read_b64_tr_b16 v[102:103], v51 offset:39424
    ds_read_b64_tr_b16 v[32:33], v51 offset:43008
    ds_read_b64_tr_b16 v[34:35], v51 offset:43520
    ds_read_b128 v[56:59], v2 offset:18432
    ds_read_b128 v[72:75], v2 offset:22528
    ds_read_b64_tr_b16 v[36:37], v51 offset:47104
    ds_read_b64_tr_b16 v[38:39], v51 offset:47616
    ds_read_b128 v[60:63], v2 offset:19456
    ds_read_b128 v[76:79], v2 offset:23552
    s_waitcnt lgkmcnt(8)
    v_mfma_f32_16x16x32_bf16 v[52:55], v[96:99], v[104:107], 0
    v_mfma_f32_16x16x32_bf16 v[52:55], v[100:103], v[108:111], v[52:55]
    ds_read_b64_tr_b16 v[40:41], v51 offset:51200
    ds_read_b64_tr_b16 v[42:43], v51 offset:51712
    ds_read_b128 v[64:67], v2 offset:20480
    ds_read_b128 v[80:83], v2 offset:24576
    s_waitcnt lgkmcnt(8)
    v_mfma_f32_16x16x32_bf16 v[12:15], v[32:35], v[56:59], 0
    v_mfma_f32_16x16x32_bf16 v[12:15], v[32:35], v[72:75], v[12:15]
    ds_read_b64_tr_b16 v[44:45], v51 offset:55296
    ds_read_b64_tr_b16 v[46:47], v51 offset:55808
    ds_read_b128 v[68:71], v2 offset:21504
    ds_read_b128 v[84:87], v2 offset:25600
    s_waitcnt lgkmcnt(8)
    v_mfma_f32_16x16x32_bf16 v[12:15], v[36:39], v[60:63], v[12:15]
    v_mfma_f32_16x16x32_bf16 v[12:15], v[36:39], v[76:79], v[12:15]
    s_waitcnt lgkmcnt(4)
    v_mfma_f32_16x16x32_bf16 v[12:15], v[40:43], v[64:67], v[12:15]
    v_mfma_f32_16x16x32_bf16 v[12:15], v[40:43], v[80:83], v[12:15]
    s_waitcnt lgkmcnt(0)
    v_mfma_f32_16x16x32_bf16 v[12:15], v[44:47], v[68:71], v[12:15]
    v_mfma_f32_16x16x32_bf16 v[12:15], v[44:47], v[84:87], v[12:15]
    s_nop 7
    v_add_f32_dpp v52, v12, v12 row_ror:8 row_mask:0xf bank_mask:0x3
    v_add_f32_dpp v53, v13, v13 row_ror:8 row_mask:0xf bank_mask:0x3
    v_add_f32_dpp v54, v14, v14 row_ror:8 row_mask:0xf bank_mask:0x3
    v_add_f32_dpp v55, v15, v15 row_ror:8 row_mask:0xf bank_mask:0x3
    v_min_u32 v52, -2, v52
    ds_bpermute_b32 v24, v21, v52
    v_min_u32 v53, -2, v53
    ds_bpermute_b32 v25, v21, v53
    v_min_u32 v54, -2, v54
    ds_bpermute_b32 v26, v21, v54
    v_min_u32 v55, -2, v55
    ds_bpermute_b32 v27, v21, v55
    s_mov_b64 exec, s[96:97]
    s_waitcnt lgkmcnt(0)
    s_cbranch_execz L_nofast
    buffer_store_dwordx4 v[24:27], v48, s[12:15], s88 offen
L_nofast:
    s_not_b64 exec, s[96:97]
    s_cbranch_execz L_noslow
    buffer_store_dwordx4 v[24:27], v48, s[12:15], s88 offen sc1
L_noslow:
    s_mov_b64 exec, -1
    s_endpgm
L_aux:
    s_cmp_lg_u32 s3, 6
    s_barrier
    s_cbranch_scc1 L_end
    s_barrier
L_fin:
    s_mul_i32 s88, s49, 86016
    s_lshl_b32 s89, s48, 12
    s_add_u32 s88, s88, s89
    ds_read_b128 v[52:55], v2 offset:28672
    s_waitcnt lgkmcnt(0)
    v_min_u32 v53, 8190, v53
    s_barrier
    s_mov_b32 s65, 0
    s_mov_b64 vcc, -1
L_h2:
    s_mov_b64 exec, vcc
    buffer_load_dwordx4 v[64:67], v2, s[12:15], s88 offen offset:0 sc1
    buffer_load_dwordx4 v[68:71], v2, s[12:15], s88 offen offset:1024 sc1
    buffer_load_dwordx4 v[72:75], v2, s[12:15], s88 offen offset:2048 sc1
    buffer_load_dwordx4 v[76:79], v2, s[12:15], s88 offen offset:3072 sc1
    s_add_u32 s65, s65, 1
    s_cmp_gt_u32 s65, 200000
    s_waitcnt vmcnt(0)
    s_cbranch_scc1 L_h2go
    v_max3_u32 v22, v64, v65, v66
    v_max3_u32 v23, v72, v73, v74
    v_max3_u32 v22, v22, v67, v68
    v_max3_u32 v23, v23, v75, v76
    v_max3_u32 v22, v22, v69, v70
    v_max3_u32 v23, v23, v77, v78
    v_max3_u32 v22, v22, v71, v79
    v_max_u32 v22, v22, v23
    v_cmp_eq_u32 vcc, -1, v22
    s_cbranch_vccnz L_h2
L_h2go:
    s_mov_b64 exec, -1
    v_add_f32 v64, v64, v68
    v_add_f32 v72, v72, v76
    v_add_f32 v65, v65, v69
    v_add_f32 v73, v73, v77
    v_add_f32 v66, v66, v70
    v_add_f32 v74, v74, v78
    v_add_f32 v67, v67, v71
    v_add_f32 v75, v75, v79
    v_add_f32 v64, v64, v72
    v_add_f32 v65, v65, v73
    v_add_f32 v66, v66, v74
    v_add_f32 v67, v67, v75
    s_nop 0
    v_permlane32_swap_b32 v64, v65
    v_permlane32_swap_b32 v66, v67
    s_nop 0
    v_add_f32 v64, v64, v65
    v_add_f32 v66, v66, v67
    s_nop 1
    v_permlane16_swap_b32 v64, v66
    s_nop 1
    v_add_f32 v64, v64, v66
    s_nop 1
    v_add_f32_dpp v64, v64, v64 row_ror:8 row_mask:0xf bank_mask:0xf
    v_cvt_pk_bf16_f32 v64, v64, v64
    v_and_b32 v64, s70, v64
    v_add_f32 v64, v64, v54
    v_cvt_pk_bf16_f32 v64, v64, v64
    v_and_b32 v64, s70, v64
    v_mul_f32 v64, v64, v52
    v_cvt_pk_bf16_f32 v64, v64, v64
    v_and_b32 v64, s70, v64
    s_nop 1
    v_add_f32_dpp v64, v64, v64 row_ror:4 row_mask:0xf bank_mask:0xf
    v_cvt_pk_bf16_f32 v64, v64, v64
    s_mov_b32 exec_lo, 0x000f000f
    s_mov_b32 exec_hi, 0x000f000f
    global_store_short v53, v64, s[38:39]
    s_mov_b64 exec, -1
    s_endpgm
L_service:
    s_setprio 3
    v_lshrrev_b32 v3, 3, v0
    v_and_b32 v22, 7, v0
    v_lshlrev_b32 v22, 4, v22
    v_lshl_add_u32 v23, v3, 13, v22
    s_lshl_b32 s94, s51, 3
    s_add_u32 s94, s94, s50
    s_lshl_b32 s66, s52, 20
    s_lshl_b32 s67, s94, 7
    s_add_u32 s66, s66, s67
    s_mov_b32 s44, s22
    s_mov_b32 s45, s23
    s_mov_b32 s46, 0x400000
    s_mov_b32 m0, 2048
    s_nop 0
    buffer_load_dwordx4 v23, s[44:47], s66 offen offset:0 nt lds
    s_add_u32 s66, s66, 64512
    buffer_load_dwordx4 v23, s[44:47], s66 offen offset:1024 nt lds
    s_add_u32 s66, s66, 64512
    buffer_load_dwordx4 v23, s[44:47], s66 offen offset:2048 nt lds
    s_add_u32 s66, s66, 64512
    buffer_load_dwordx4 v23, s[44:47], s66 offen offset:3072 nt lds
    s_mov_b32 m0, 6144
    s_add_u32 s66, s66, 68608
    buffer_load_dwordx4 v23, s[44:47], s66 offen offset:0 nt lds
    s_add_u32 s66, s66, 64512
    buffer_load_dwordx4 v23, s[44:47], s66 offen offset:1024 nt lds
    s_add_u32 s66, s66, 64512
    buffer_load_dwordx4 v23, s[44:47], s66 offen offset:2048 nt lds
    s_add_u32 s66, s66, 64512
    buffer_load_dwordx4 v23, s[44:47], s66 offen offset:3072 nt lds
    s_mov_b32 m0, 10240
    s_add_u32 s66, s66, 68608
    buffer_load_dwordx4 v23, s[44:47], s66 offen offset:0 nt lds
    s_add_u32 s66, s66, 64512
    buffer_load_dwordx4 v23, s[44:47], s66 offen offset:1024 nt lds
    s_add_u32 s66, s66, 64512
    buffer_load_dwordx4 v23, s[44:47], s66 offen offset:2048 nt lds
    s_add_u32 s66, s66, 64512
    buffer_load_dwordx4 v23, s[44:47], s66 offen offset:3072 nt lds
    s_mov_b32 m0, 14336
    s_add_u32 s66, s66, 68608
    buffer_load_dwordx4 v23, s[44:47], s66 offen offset:0 nt lds
    s_add_u32 s66, s66, 64512
    buffer_load_dwordx4 v23, s[44:47], s66 offen offset:1024 nt lds
    s_add_u32 s66, s66, 64512
    buffer_load_dwordx4 v23, s[44:47], s66 offen offset:2048 nt lds
    s_add_u32 s66, s66, 64512
    buffer_load_dwordx4 v23, s[44:47], s66 offen offset:3072 nt lds
    v_mul_u32_u24 v24, 3584, v3
    v_add_u32 v24, v24, v22
    v_and_b32 v3, 7, v0
    v_lshlrev_b32 v3, 10, v3
    v_lshrrev_b32 v22, 4, v0
    v_lshl_add_u32 v3, v22, 4, v3
    s_lshl_b32 s66, s52, 8
    v_add_u32 v22, s66, v3
    global_load_dwordx4 v[200:203], v22, s[16:17] offset:0
    global_load_dwordx4 v[204:207], v22, s[16:17] offset:64
    global_load_dwordx4 v[208:211], v22, s[16:17] offset:128
    global_load_dwordx4 v[212:215], v22, s[16:17] offset:192
    s_lshl_b32 s66, s48, 7
    v_add_u32 v22, s66, v3
    global_load_dwordx4 v[192:195], v22, s[16:17] offset:0
    global_load_dwordx4 v[196:199], v22, s[16:17] offset:64
    s_mul_i32 s66, s48, 229376
    s_lshl_b32 s67, s49, 7
    s_add_u32 s66, s66, s67
    s_cmp_lt_u32 s49, 28
    s_cselect_b32 s66, s66, 0x7f000000
    s_mov_b32 s44, s28
    s_mov_b32 s45, s29
    s_mov_b32 s46, 1835008
    s_mov_b32 m0, 18432
    s_nop 0
    buffer_load_dwordx4 v24, s[44:47], s66 offen offset:0 nt lds
    s_add_u32 s66, s66, 27648
    buffer_load_dwordx4 v24, s[44:47], s66 offen offset:1024 nt lds
    s_add_u32 s66, s66, 27648
    buffer_load_dwordx4 v24, s[44:47], s66 offen offset:2048 nt lds
    s_add_u32 s66, s66, 27648
    buffer_load_dwordx4 v24, s[44:47], s66 offen offset:3072 nt lds
    s_mov_b32 m0, 22528
    s_add_u32 s66, s66, 31744
    buffer_load_dwordx4 v24, s[44:47], s66 offen offset:0 nt lds
    s_add_u32 s66, s66, 27648
    buffer_load_dwordx4 v24, s[44:47], s66 offen offset:1024 nt lds
    s_add_u32 s66, s66, 27648
    buffer_load_dwordx4 v24, s[44:47], s66 offen offset:2048 nt lds
    s_add_u32 s66, s66, 27648
    buffer_load_dwordx4 v24, s[44:47], s66 offen offset:3072 nt lds
    s_barrier
    s_lshr_b32 s98, s94, 1
    s_mul_i32 s98, s98, 86016
    s_and_b32 s66, s50, 1
    s_lshl_b32 s66, s66, 2
    s_add_u32 s66, s66, s52
    s_lshl_b32 s66, s66, 7
    s_add_u32 s98, s98, s66
    s_add_u32 s97, s98, 44032
    s_add_u32 s98, s98, 45056
    s_getreg_b32 s67, hwreg(HW_REG_XCC_ID)
    s_mul_i32 s90, s49, 86016
    v_mov_b32 v60, s67
    s_lshl_b32 s67, s48, 7
    s_add_u32 s101, s90, s67
    s_add_u32 s66, s101, 46080
    s_add_u32 s101, s101, 43008
    v_mov_b32 v56, -1
    v_mov_b32 v57, -1
    v_mov_b32 v58, -1
    v_mov_b32 v59, -1
    s_mov_b64 exec, 1
    buffer_store_dwordx2 v[4:5], v4, s[12:15], s98 offen sc1
    buffer_store_dword v60, v4, s[12:15], s66 offen sc1
    s_mov_b64 exec, 0xff
    buffer_store_dwordx4 v[56:59], v2, s[12:15], s97 offen sc1
    buffer_store_dwordx4 v[56:59], v2, s[12:15], s101 offen sc1
    s_mov_b64 exec, -1
    v_lshrrev_b32 v51, 4, v0
    v_mul_u32_u24 v29, 86016, v51
    v_bfe_u32 v3, v0, 3, 1
    v_lshl_add_u32 v50, v3, 11, v29
    v_and_b32 v3, 7, v0
    v_lshl_add_u32 v50, v3, 4, v50
    s_mul_i32 s71, s51, 344064
    s_and_b32 s96, s52, 1
    s_lshl_b32 s96, s96, 3
    s_add_u32 s96, s96, s50
    s_lshl_b32 s96, s96, 7
    s_lshr_b32 s66, s52, 1
    s_lshl_b32 s66, s66, 12
    s_add_u32 s96, s96, s66
    s_add_u32 s96, s96, s71
    s_add_u32 s96, s96, 32768
    buffer_store_dwordx4 v[56:59], v50, s[12:15], s96 offen sc1
    s_add_u32 s99, s71, 45056
    s_lshl_b32 s88, s48, 12
    s_add_u32 s88, s88, s90
    buffer_store_dwordx4 v[56:59], v2, s[12:15], s88 offen offset:0 sc1
    buffer_store_dwordx4 v[56:59], v2, s[12:15], s88 offen offset:1024 sc1
    buffer_store_dwordx4 v[56:59], v2, s[12:15], s88 offen offset:2048 sc1
    buffer_store_dwordx4 v[56:59], v2, s[12:15], s88 offen offset:3072 sc1
    v_lshrrev_b32 v28, 4, v0
    v_bfe_u32 v31, v0, 2, 2
    v_lshl_add_u32 v28, v28, 3, v31
    v_lshlrev_b32 v28, 7, v28
    v_and_b32 v31, 3, v0
    v_lshl_add_u32 v28, v31, 3, v28
    v_lshlrev_b32 v27, 7, v3
    v_lshl_add_u32 v30, v51, 4, v27
    v_lshlrev_b32 v46, 8, v3
    v_lshl_add_u32 v46, v51, 4, v46
    v_and_b32 v3, 15, v0
    v_lshlrev_b32 v3, 4, v3
    v_add_u32 v29, v29, v3
    v_lshl_add_u32 v27, v51, 11, v3
    v_lshlrev_b32 v51, 3, v51
    s_mul_i32 s66, s52, 688128
    s_lshl_b32 s67, s94, 8
    s_add_u32 s66, s66, s67
    s_add_u32 s66, s66, 49152
    s_waitcnt vmcnt(0)
    ds_read_b64_tr_b16 v[64:65], v28 offset:2048
    ds_read_b64_tr_b16 v[66:67], v28 offset:2560
    ds_read_b64_tr_b16 v[68:69], v28 offset:2080
    ds_read_b64_tr_b16 v[70:71], v28 offset:2592
    ds_read_b64_tr_b16 v[72:73], v28 offset:2112
    ds_read_b64_tr_b16 v[74:75], v28 offset:2624
    ds_read_b64_tr_b16 v[76:77], v28 offset:2144
    ds_read_b64_tr_b16 v[78:79], v28 offset:2656
    ds_read_b64_tr_b16 v[80:81], v28 offset:6144
    ds_read_b64_tr_b16 v[82:83], v28 offset:6656
    ds_read_b64_tr_b16 v[84:85], v28 offset:6176
    ds_read_b64_tr_b16 v[86:87], v28 offset:6688
    ds_read_b64_tr_b16 v[88:89], v28 offset:6208
    ds_read_b64_tr_b16 v[90:91], v28 offset:6720
    ds_read_b64_tr_b16 v[92:93], v28 offset:6240
    ds_read_b64_tr_b16 v[94:95], v28 offset:6752
    s_waitcnt lgkmcnt(8)
    v_mfma_f32_16x16x32_bf16 v[128:131], v[64:67], v[200:203], 0
    v_mfma_f32_16x16x32_bf16 v[132:135], v[68:71], v[200:203], 0
    v_mfma_f32_16x16x32_bf16 v[136:139], v[72:75], v[200:203], 0
    v_mfma_f32_16x16x32_bf16 v[140:143], v[76:79], v[200:203], 0
    ds_read_b64_tr_b16 v[96:97], v28 offset:10240
    ds_read_b64_tr_b16 v[98:99], v28 offset:10752
    ds_read_b64_tr_b16 v[100:101], v28 offset:10272
    ds_read_b64_tr_b16 v[102:103], v28 offset:10784
    ds_read_b64_tr_b16 v[104:105], v28 offset:10304
    ds_read_b64_tr_b16 v[106:107], v28 offset:10816
    ds_read_b64_tr_b16 v[108:109], v28 offset:10336
    ds_read_b64_tr_b16 v[110:111], v28 offset:10848
    s_waitcnt lgkmcnt(8)
    v_mfma_f32_16x16x32_bf16 v[128:131], v[80:83], v[204:207], v[128:131]
    v_mfma_f32_16x16x32_bf16 v[132:135], v[84:87], v[204:207], v[132:135]
    v_mfma_f32_16x16x32_bf16 v[136:139], v[88:91], v[204:207], v[136:139]
    v_mfma_f32_16x16x32_bf16 v[140:143], v[92:95], v[204:207], v[140:143]
    ds_read_b64_tr_b16 v[112:113], v28 offset:14336
    ds_read_b64_tr_b16 v[114:115], v28 offset:14848
    ds_read_b64_tr_b16 v[116:117], v28 offset:14368
    ds_read_b64_tr_b16 v[118:119], v28 offset:14880
    ds_read_b64_tr_b16 v[120:121], v28 offset:14400
    ds_read_b64_tr_b16 v[122:123], v28 offset:14912
    ds_read_b64_tr_b16 v[124:125], v28 offset:14432
    ds_read_b64_tr_b16 v[126:127], v28 offset:14944
    s_waitcnt lgkmcnt(8)
    v_mfma_f32_16x16x32_bf16 v[128:131], v[96:99], v[208:211], v[128:131]
    v_mfma_f32_16x16x32_bf16 v[132:135], v[100:103], v[208:211], v[132:135]
    v_mfma_f32_16x16x32_bf16 v[136:139], v[104:107], v[208:211], v[136:139]
    v_mfma_f32_16x16x32_bf16 v[140:143], v[108:111], v[208:211], v[140:143]
    ds_read_b64_tr_b16 v[160:161], v28 offset:18432
    ds_read_b64_tr_b16 v[162:163], v28 offset:18944
    ds_read_b64_tr_b16 v[164:165], v28 offset:18464
    ds_read_b64_tr_b16 v[166:167], v28 offset:18976
    ds_read_b64_tr_b16 v[168:169], v28 offset:18496
    ds_read_b64_tr_b16 v[170:171], v28 offset:19008
    ds_read_b64_tr_b16 v[172:173], v28 offset:18528
    ds_read_b64_tr_b16 v[174:175], v28 offset:19040
    s_waitcnt lgkmcnt(8)
    v_mfma_f32_16x16x32_bf16 v[128:131], v[112:115], v[212:215], v[128:131]
    v_mfma_f32_16x16x32_bf16 v[132:135], v[116:119], v[212:215], v[132:135]
    v_mfma_f32_16x16x32_bf16 v[136:139], v[120:123], v[212:215], v[136:139]
    v_mfma_f32_16x16x32_bf16 v[140:143], v[124:127], v[212:215], v[140:143]
    ds_read_b64_tr_b16 v[176:177], v28 offset:22528
    ds_read_b64_tr_b16 v[178:179], v28 offset:23040
    ds_read_b64_tr_b16 v[180:181], v28 offset:22560
    ds_read_b64_tr_b16 v[182:183], v28 offset:23072
    ds_read_b64_tr_b16 v[184:185], v28 offset:22592
    ds_read_b64_tr_b16 v[186:187], v28 offset:23104
    ds_read_b64_tr_b16 v[188:189], v28 offset:22624
    ds_read_b64_tr_b16 v[190:191], v28 offset:23136
    ds_write_b128 v46, v[128:131] offset:30720
    ds_write_b128 v46, v[132:135] offset:30784
    ds_write_b128 v46, v[136:139] offset:30848
    ds_write_b128 v46, v[140:143] offset:30912
    s_add_u32 s67, s66, 344064
    s_waitcnt lgkmcnt(0)
    ds_read_b128 v[128:131], v2 offset:30720
    ds_read_b128 v[132:135], v2 offset:31744
    v_mfma_f32_16x16x32_bf16 v[144:147], v[160:163], v[192:195], 0
    v_mfma_f32_16x16x32_bf16 v[148:151], v[164:167], v[192:195], 0
    v_mfma_f32_16x16x32_bf16 v[152:155], v[168:171], v[192:195], 0
    v_mfma_f32_16x16x32_bf16 v[156:159], v[172:175], v[192:195], 0
    v_mfma_f32_16x16x32_bf16 v[144:147], v[176:179], v[196:199], v[144:147]
    v_mfma_f32_16x16x32_bf16 v[148:151], v[180:183], v[196:199], v[148:151]
    v_mfma_f32_16x16x32_bf16 v[152:155], v[184:187], v[196:199], v[152:155]
    v_mfma_f32_16x16x32_bf16 v[156:159], v[188:191], v[196:199], v[156:159]
    s_waitcnt lgkmcnt(0)
    buffer_store_dwordx4 v[128:131], v29, s[12:15], s66 offen sc1
    buffer_store_dwordx4 v[132:135], v29, s[12:15], s67 offen sc1
    s_lshl_b32 s67, s48, 8
    s_add_u32 s66, s90, s67
    s_add_u32 s66, s66, 65536
    s_add_u32 s67, s66, 8192
    s_cmp_ge_u32 s49, 28
    s_cbranch_scc1 L_nohp
    ds_write_b128 v46, v[144:147] offset:32768
    ds_write_b128 v46, v[148:151] offset:32832
    ds_write_b128 v46, v[152:155] offset:32896
    ds_write_b128 v46, v[156:159] offset:32960
    s_waitcnt lgkmcnt(0)
    ds_read_b128 v[136:139], v2 offset:32768
    ds_read_b128 v[140:143], v2 offset:33792
    s_waitcnt lgkmcnt(0)
    buffer_store_dwordx4 v[136:139], v27, s[12:15], s66 offen sc1
    buffer_store_dwordx4 v[140:143], v27, s[12:15], s67 offen sc1
L_nohp:
    s_mul_i32 s66, s50, 86016
    s_lshl_b32 s67, s51, 11
    s_add_u32 s94, s66, s67
    s_add_u32 s94, s94, 49152
    s_lshl_b32 s95, s48, 11
    s_add_u32 s95, s95, s90
    s_add_u32 s95, s95, 65536
    s_cmp_lt_u32 s49, 28
    s_cselect_b32 s95, s95, 0x7f000000
    s_add_u32 s56, s53, 258048
    v_lshrrev_b32 v22, 4, v0
    v_lshrrev_b32 v23, 1, v22
    v_and_b32 v22, 1, v22
    v_lshl_add_u32 v22, v22, 1, v23
    v_and_b32 v23, 15, v0
    v_lshl_add_u32 v45, v23, 2, v22
    v_and_b32 v22, 15, v45
    v_lshlrev_b32 v45, 1, v45
    s_and_b32 s67, s49, 3
    s_lshl_b32 s67, s67, 4
    s_lshl_b32 s71, s48, 6
    s_add_u32 s67, s67, s71
    v_add_u32 v22, s67, v22
    v_lshlrev_b32 v41, 1, v22
    s_lshr_b32 s71, s49, 2
    s_lshl_b32 s71, s71, 10
    v_add_u32 v3, s71, v2
    v_lshrrev_b32 v7, 3, v0
    v_and_b32 v24, 7, v0
    v_mul_u32_u24 v7, 86016, v7
    v_lshl_add_u32 v7, v24, 7, v7
    s_lshl_b32 s66, s51, 5
    v_mov_b32 v22, s66
    v_mov_b32 v31, 1
    v_mov_b32 v6, 1
    s_mov_b32 s44, s30
    s_mov_b32 s45, s31
    s_mov_b32 s46, 3584
    s_lshl_b32 s66, s49, 7
    s_waitcnt vmcnt(0)
    s_mov_b64 exec, 1
    global_atomic_add v31, v22, v31, s[40:41] sc0 sc1
    s_mov_b64 exec, -1
    global_load_dwordx4 v[32:35], v3, s[16:17]
    global_load_dwordx4 v[36:39], v2, s[36:37]
    global_load_ushort v42, v41, s[34:35]
    v_add_u32 v41, s71, v41
    buffer_load_dwordx4 v[52:55], v1, s[4:7], s56 offen offset:0 nt
    buffer_load_dwordx4 v[160:163], v2, s[8:11], s56 offen offset:0 nt
    buffer_load_dwordx4 v[56:59], v1, s[4:7], s56 offen offset:1024 nt
    buffer_load_dwordx4 v[164:167], v2, s[8:11], s56 offen offset:1024 nt
    buffer_load_dwordx4 v[60:63], v1, s[4:7], s56 offen offset:2048 nt
    buffer_load_dwordx4 v[168:171], v2, s[8:11], s56 offen offset:2048 nt
    buffer_load_dwordx4 v[64:67], v1, s[4:7], s56 offen offset:3072 nt
    buffer_load_dwordx4 v[172:175], v2, s[8:11], s56 offen offset:3072 nt
    s_waitcnt vmcnt(11)
    v_readfirstlane_b32 s100, v31
    buffer_load_ushort v44, v45, s[44:47], s66 offen
    s_mov_b32 s65, 0
    s_and_b32 s100, s100, 31
    s_cmp_lg_u32 s100, 31
    s_cbranch_scc1 L_bar
    s_mov_b32 exec_hi, 0
    buffer_store_dword v6, v7, s[12:15], s99 offen sc1
    s_mov_b64 exec, 1
    v_mov_b32 v31, 1
    global_atomic_add v31, v4, v31, s[40:41] offset:16 sc0 sc1
    s_mov_b64 exec, -1
    s_branch L_bargo
L_bar:
    s_sleep 16
    s_load_dwordx2 s[92:93], s[42:43], s98 glc
    s_add_u32 s65, s65, 1
    s_waitcnt lgkmcnt(0)
    s_cmp_gt_u32 s65, 200000
    s_cbranch_scc1 L_bargo
    s_cmp_eq_u32 s92, 0
    s_cbranch_scc1 L_bar
L_bargo:
    buffer_load_dwordx4 v[128:131], v2, s[12:15], s94 offen offset:0 sc1
    buffer_load_dwordx4 v[132:135], v2, s[12:15], s94 offen offset:1024 sc1
    s_add_u32 s94, s94, 688128
    buffer_load_dwordx4 v[136:139], v2, s[12:15], s94 offen offset:0 sc1
    buffer_load_dwordx4 v[140:143], v2, s[12:15], s94 offen offset:1024 sc1
    s_add_u32 s94, s94, 688128
    buffer_load_dwordx4 v[144:147], v2, s[12:15], s94 offen offset:0 sc1
    buffer_load_dwordx4 v[148:151], v2, s[12:15], s94 offen offset:1024 sc1
    s_add_u32 s94, s94, 688128
    buffer_load_dwordx4 v[152:155], v2, s[12:15], s94 offen offset:0 sc1
    buffer_load_dwordx4 v[156:159], v2, s[12:15], s94 offen offset:1024 sc1
    buffer_load_dwordx4 v[104:107], v2, s[12:15], s95 offen sc1
    buffer_load_dwordx4 v[108:111], v2, s[12:15], s95 offen offset:1024 sc1
    v_lshlrev_b32 v23, 3, v0
    s_waitcnt vmcnt(0)
    v_add_f32 v128, v128, v136
    v_add_f32 v144, v144, v152
    v_add_f32 v129, v129, v137
    v_add_f32 v145, v145, v153
    v_add_f32 v130, v130, v138
    v_add_f32 v146, v146, v154
    v_add_f32 v131, v131, v139
    v_add_f32 v147, v147, v155
    v_add_f32 v132, v132, v140
    v_add_f32 v148, v148, v156
    v_add_f32 v133, v133, v141
    v_add_f32 v149, v149, v157
    v_add_f32 v134, v134, v142
    v_add_f32 v150, v150, v158
    v_add_f32 v135, v135, v143
    v_add_f32 v151, v151, v159
    v_add_f32 v128, v128, v144
    v_add_f32 v129, v129, v145
    v_add_f32 v130, v130, v146
    v_add_f32 v131, v131, v147
    v_add_f32 v132, v132, v148
    v_add_f32 v133, v133, v149
    v_add_f32 v134, v134, v150
    v_add_f32 v135, v135, v151
    v_cvt_pk_bf16_f32 v136, v128, v129
    v_cvt_pk_bf16_f32 v137, v130, v131
    v_cvt_pk_bf16_f32 v138, v132, v133
    v_cvt_pk_bf16_f32 v139, v134, v135
    ds_write_b64 v23, v[136:137] offset:1024
    ds_write_b64 v23, v[138:139] offset:1536
    s_cmp_lg_u32 s100, 31
    s_waitcnt lgkmcnt(0)
    ds_write_b32 v4, v6
    ds_read_b128 v[120:123], v1 offset:1024
    s_waitcnt vmcnt(0)
    s_cbranch_scc1 L_nottop
    v_readfirstlane_b32 s67, v31
    s_nop 0
    s_and_b32 s67, s67, 7
    s_cmp_lg_u32 s67, 7
    s_cbranch_scc1 L_nottop
    s_mov_b32 s71, 45060
    buffer_store_dword v6, v7, s[12:15], s71 offen sc1
    s_add_u32 s71, s71, 688128
    buffer_store_dword v6, v7, s[12:15], s71 offen sc1
    s_add_u32 s71, s71, 688128
    buffer_store_dword v6, v7, s[12:15], s71 offen sc1
    s_add_u32 s71, s71, 688128
    buffer_store_dword v6, v7, s[12:15], s71 offen sc1
L_nottop:
    s_setprio 0
    v_lshlrev_b32 v44, 16, v44
    v_add_f32 v104, v104, v108
    v_add_f32 v105, v105, v109
    v_add_f32 v106, v106, v110
    v_add_f32 v107, v107, v111
    s_nop 0
    v_permlane32_swap_b32 v104, v105
    v_permlane32_swap_b32 v106, v107
    s_nop 0
    v_add_f32 v104, v104, v105
    v_add_f32 v106, v106, v107
    s_nop 1
    v_permlane16_swap_b32 v104, v106
    s_nop 1
    v_add_f32 v104, v104, v106
    v_cvt_pk_bf16_f32 v104, v104, v104
    v_and_b32 v104, s70, v104
    v_add_f32 v104, v104, v44
    v_cvt_pk_bf16_f32 v104, v104, v104
    v_and_b32 v104, s70, v104
    v_max_f32 v104, 0, v104
    v_mul_f32 v104, v104, v104
    v_cvt_pk_bf16_f32 v104, v104, v104
    ds_write_b16 v45, v104 offset:30720
    s_waitcnt lgkmcnt(0)
    ds_read_b128 v[104:107], v2 offset:30720
    v_mov_b32 v4, v120
    v_mov_b32 v5, v121
    v_mov_b32 v6, v122
    v_mov_b32 v7, v123
    s_waitcnt lgkmcnt(0)
    v_min_u32 v104, -2, v104
    v_min_u32 v105, -2, v105
    v_min_u32 v106, -2, v106
    v_min_u32 v107, -2, v107
    s_mov_b64 exec, 0xff
    buffer_store_dwordx4 v[104:107], v2, s[12:15], s101 offen sc1
    s_mov_b64 exec, -1
    v_lshlrev_b32 v144, 16, v32
    v_and_b32 v145, s70, v32
    v_lshlrev_b32 v152, 16, v36
    v_and_b32 v153, s70, v36
    v_lshlrev_b32 v146, 16, v33
    v_and_b32 v147, s70, v33
    v_lshlrev_b32 v154, 16, v37
    v_and_b32 v155, s70, v37
    v_lshlrev_b32 v148, 16, v34
    v_and_b32 v149, s70, v34
    v_lshlrev_b32 v156, 16, v38
    v_and_b32 v157, s70, v38
    v_lshlrev_b32 v150, 16, v35
    v_and_b32 v151, s70, v35
    v_lshlrev_b32 v158, 16, v39
    v_and_b32 v159, s70, v39
    v_mul_f32 v144, v144, v152
    v_mul_f32 v145, v145, v153
    v_mul_f32 v146, v146, v154
    v_mul_f32 v147, v147, v155
    v_mul_f32 v148, v148, v156
    v_mul_f32 v149, v149, v157
    v_mul_f32 v150, v150, v158
    v_mul_f32 v151, v151, v159
    v_cvt_pk_bf16_f32 v152, v144, v145
    v_cvt_pk_bf16_f32 v153, v146, v147
    v_cvt_pk_bf16_f32 v154, v148, v149
    v_cvt_pk_bf16_f32 v155, v150, v151
    v_lshlrev_b32 v144, 16, v152
    v_and_b32 v145, s70, v152
    v_lshlrev_b32 v146, 16, v153
    v_and_b32 v147, s70, v153
    v_lshlrev_b32 v148, 16, v154
    v_and_b32 v149, s70, v154
    v_lshlrev_b32 v150, 16, v155
    v_and_b32 v151, s70, v155
    v_add_f32 v144, v144, v145
    v_add_f32 v146, v146, v147
    v_add_f32 v148, v148, v149
    v_add_f32 v150, v150, v151
    v_add_f32 v144, v144, v146
    v_add_f32 v148, v148, v150
    v_add_f32 v40, v144, v148
    s_nop 1
    v_add_f32_dpp v40, v40, v40 quad_perm:[1,0,3,2] row_mask:0xf bank_mask:0xf
    s_nop 1
    v_add_f32_dpp v40, v40, v40 quad_perm:[2,3,0,1] row_mask:0xf bank_mask:0xf
    s_nop 1
    v_add_f32_dpp v40, v40, v40 row_ror:4 row_mask:0xf bank_mask:0xf
    s_nop 1
    v_add_f32_dpp v40, v40, v40 row_ror:8 row_mask:0xf bank_mask:0xf
    v_mov_b32 v22, v40
    s_nop 1
    v_permlane16_swap_b32 v40, v22
    s_nop 1
    v_add_f32 v40, v40, v22
    v_mov_b32 v22, v40
    s_nop 1
    v_permlane32_swap_b32 v40, v22
    s_nop 1
    v_add_f32 v40, v40, v22
    v_cvt_pk_bf16_f32 v40, v40, v40
    v_and_b32 v40, s70, v40
    v_mul_f32 v40, s69, v40
    v_exp_f32 v40, -v40
    s_nop 0
    v_add_f32 v40, 1.0, v40
    v_rcp_f32 v40, v40
    s_nop 0
    v_cvt_pk_bf16_f32 v40, v40, v40
    v_and_b32 v40, s70, v40
    v_sub_f32 v43, 1.0, v40
    v_cvt_pk_bf16_f32 v43, v43, v43
    v_and_b32 v43, s70, v43
    v_lshlrev_b32 v42, 16, v42
    s_mov_b32 s66, 0xf0f0f0f0
    s_mov_b32 s67, 0xf0f0f0f0
    v_cndmask_b32 v40, v40, v43, s[66:67]
    v_cndmask_b32 v42, 0, v42, s[66:67]
    ds_write_b128 v2, v[40:43] offset:28672
    v_and_b32 v3, 1, v0
    v_cmp_eq_u32 vcc, 0, v3
    v_mov_b32 v22, 0x0c0c0100
    v_mov_b32 v23, 0x0c0c0302
    v_mov_b32 v24, 0x01000c0c
    v_mov_b32 v25, 0x03020c0c
    v_cndmask_b32 v22, v24, v22, vcc
    v_cndmask_b32 v23, v25, v23, vcc
    v_and_b32 v3, 2, v0
    v_cmp_eq_u32 vcc, 0, v3
    v_mov_b32 v24, 0x0c0c0c0c
    v_mov_b32 v20, 0xff800000
    v_cndmask_b32 v8, v24, v22, vcc
    v_cndmask_b32 v9, v22, v24, vcc
    v_cndmask_b32 v10, v24, v23, vcc
    v_cndmask_b32 v11, v23, v24, vcc
    v_mov_b32 v12, 0
    v_mov_b32 v13, 0
    v_mov_b32 v14, 0
    v_mov_b32 v15, 0
    v_mov_b32 v16, 0
    v_mov_b32 v17, 0
    v_mov_b32 v18, 0
    v_mov_b32 v19, 0
    v_mov_b32 v21, 0
    v_mfma_f32_16x16x32_bf16 v[52:55], v[52:55], v[4:7], 0
    v_mfma_f32_16x16x32_bf16 v[56:59], v[56:59], v[4:7], 0
    v_mfma_f32_16x16x32_bf16 v[60:63], v[60:63], v[4:7], 0
    v_mfma_f32_16x16x32_bf16 v[64:67], v[64:67], v[4:7], 0
    s_nop 3
    s_nop 3
    v_mov_b32_dpp v22, v52 quad_perm:[0,0,0,0] row_mask:0xf bank_mask:0xf
    v_mov_b32_dpp v23, v56 quad_perm:[0,0,0,0] row_mask:0xf bank_mask:0xf
    v_mov_b32_dpp v24, v60 quad_perm:[0,0,0,0] row_mask:0xf bank_mask:0xf
    v_mov_b32_dpp v25, v64 quad_perm:[0,0,0,0] row_mask:0xf bank_mask:0xf
    v_add_f32_dpp v22, v53, v22 quad_perm:[1,1,1,1] row_mask:0xf bank_mask:0xf
    v_add_f32_dpp v23, v57, v23 quad_perm:[1,1,1,1] row_mask:0xf bank_mask:0xf
    v_add_f32_dpp v24, v61, v24 quad_perm:[1,1,1,1] row_mask:0xf bank_mask:0xf
    v_add_f32_dpp v25, v65, v25 quad_perm:[1,1,1,1] row_mask:0xf bank_mask:0xf
    v_add_f32_dpp v22, v54, v22 quad_perm:[2,2,2,2] row_mask:0xf bank_mask:0xf
    v_add_f32_dpp v23, v58, v23 quad_perm:[2,2,2,2] row_mask:0xf bank_mask:0xf
    v_add_f32_dpp v24, v62, v24 quad_perm:[2,2,2,2] row_mask:0xf bank_mask:0xf
    v_add_f32_dpp v25, v66, v25 quad_perm:[2,2,2,2] row_mask:0xf bank_mask:0xf
    v_add_f32_dpp v22, v55, v22 quad_perm:[3,3,3,3] row_mask:0xf bank_mask:0xf
    v_add_f32_dpp v23, v59, v23 quad_perm:[3,3,3,3] row_mask:0xf bank_mask:0xf
    v_add_f32_dpp v24, v63, v24 quad_perm:[3,3,3,3] row_mask:0xf bank_mask:0xf
    v_add_f32_dpp v25, v67, v25 quad_perm:[3,3,3,3] row_mask:0xf bank_mask:0xf
    v_cvt_pk_bf16_f32 v26, v22, v23
    v_cvt_pk_bf16_f32 v27, v24, v25
    v_lshlrev_b32 v22, 16, v26
    v_and_b32 v23, s70, v26
    v_lshlrev_b32 v24, 16, v27
    v_and_b32 v25, s70, v27
    v_mul_f32 v22, s68, v22
    v_mul_f32 v23, s68, v23
    v_mul_f32 v24, s68, v24
    v_mul_f32 v25, s68, v25
    v_cvt_pk_bf16_f32 v32, v22, v23
    v_cvt_pk_bf16_f32 v33, v24, v25
    v_max3_f32 v20, v20, v22, v23
    v_max3_f32 v20, v20, v24, v25
    v_mov_b32 v22, v20
    s_nop 1
    v_permlane16_swap_b32 v20, v22
    s_nop 1
    v_max_f32 v20, v20, v22
    v_mov_b32 v22, v20
    s_nop 1
    v_permlane32_swap_b32 v20, v22
    s_nop 1
    v_max_f32 v20, v20, v22
    v_cvt_pk_bf16_f32 v20, v20, v20
    v_and_b32 v20, s70, v20
    v_lshlrev_b32 v22, 16, v32
    v_and_b32 v23, s70, v32
    v_sub_f32 v22, v22, v20
    v_sub_f32 v23, v23, v20
    v_mul_f32 v22, s69, v22
    v_mul_f32 v23, s69, v23
    v_exp_f32 v22, v22
    v_exp_f32 v23, v23
    s_nop 0
    v_add_f32 v21, v21, v22
    v_cvt_pk_bf16_f32 v32, v22, v23
    v_add_f32 v21, v21, v23
    v_lshlrev_b32 v24, 16, v33
    v_and_b32 v25, s70, v33
    v_sub_f32 v24, v24, v20
    v_sub_f32 v25, v25, v20
    v_mul_f32 v24, s69, v24
    v_mul_f32 v25, s69, v25
    v_exp_f32 v24, v24
    v_exp_f32 v25, v25
    s_nop 0
    v_add_f32 v21, v21, v24
    v_cvt_pk_bf16_f32 v33, v24, v25
    v_add_f32 v21, v21, v25
    v_mov_b32 v22, v21
    s_nop 1
    v_permlane16_swap_b32 v21, v22
    s_nop 1
    v_add_f32 v21, v21, v22
    v_mov_b32 v22, v21
    s_nop 1
    v_permlane32_swap_b32 v21, v22
    s_nop 1
    v_add_f32 v21, v21, v22
    v_perm_b32 v22, v32, v32, v8
    v_perm_b32 v23, v32, v32, v9
    v_perm_b32 v24, v32, v32, v10
    v_perm_b32 v25, v32, v32, v11
    s_nop 0
    v_mfma_f32_16x16x16_bf16 v[12:15], v[22:23], v[160:161], v[12:15]
    v_mfma_f32_16x16x16_bf16 v[16:19], v[22:23], v[162:163], v[16:19]
    v_perm_b32 v26, v33, v33, v8
    v_perm_b32 v27, v33, v33, v9
    v_mfma_f32_16x16x16_bf16 v[12:15], v[24:25], v[164:165], v[12:15]
    v_mfma_f32_16x16x16_bf16 v[16:19], v[24:25], v[166:167], v[16:19]
    v_perm_b32 v22, v33, v33, v10
    v_perm_b32 v23, v33, v33, v11
    v_mfma_f32_16x16x16_bf16 v[12:15], v[26:27], v[168:169], v[12:15]
    v_mfma_f32_16x16x16_bf16 v[16:19], v[26:27], v[170:171], v[16:19]
    v_mfma_f32_16x16x16_bf16 v[12:15], v[22:23], v[172:173], v[12:15]
    v_mfma_f32_16x16x16_bf16 v[16:19], v[22:23], v[174:175], v[16:19]
    v_bfe_u32 v3, v0, 2, 2
    v_lshlrev_b32 v3, 6, v3
    s_lshl_b32 s66, s3, 3
    v_add_u32 v3, s66, v3
    ds_write_b64 v3, v[20:21] offset:256
    v_mov_b32 v3, 0
    s_mov_b32 s66, 0
L_stw:
    ds_read_b32 v22, v3 offset:4
    s_add_u32 s66, s66, 1
    s_waitcnt lgkmcnt(0)
    s_cmp_gt_u32 s66, 1600000
    s_cbranch_scc1 L_stwgo
    v_readfirstlane_b32 s67, v22
    s_nop 0
    s_cmp_eq_u32 s67, 7
    s_cbranch_scc1 L_stwgo
    s_sleep 4
    s_branch L_stw
L_stwgo:
    v_lshlrev_b32 v3, 3, v51
    ds_read_b128 v[144:147], v3 offset:256
    ds_read_b128 v[148:151], v3 offset:272
    ds_read_b128 v[152:155], v3 offset:288
    ds_read_b128 v[156:159], v3 offset:304
    s_waitcnt lgkmcnt(0)
    v_max3_f32 v20, v144, v146, v148
    v_max3_f32 v20, v20, v150, v152
    v_max3_f32 v20, v20, v154, v156
    v_max_f32 v20, v20, v158
    v_sub_f32 v144, v144, v20
    v_sub_f32 v146, v146, v20
    v_sub_f32 v148, v148, v20
    v_sub_f32 v150, v150, v20
    v_sub_f32 v152, v152, v20
    v_sub_f32 v154, v154, v20
    v_sub_f32 v156, v156, v20
    v_sub_f32 v158, v158, v20
    v_mul_f32 v144, s69, v144
    v_mul_f32 v146, s69, v146
    v_mul_f32 v148, s69, v148
    v_mul_f32 v150, s69, v150
    v_mul_f32 v152, s69, v152
    v_mul_f32 v154, s69, v154
    v_mul_f32 v156, s69, v156
    v_mul_f32 v158, s69, v158
    v_exp_f32 v144, v144
    v_exp_f32 v146, v146
    v_exp_f32 v148, v148
    v_exp_f32 v150, v150
    v_exp_f32 v152, v152
    v_exp_f32 v154, v154
    v_exp_f32 v156, v156
    v_exp_f32 v158, v158
    s_nop 0
    v_mul_f32 v21, v144, v145
    v_fmac_f32 v21, v146, v147
    v_fmac_f32 v21, v148, v149
    v_fmac_f32 v21, v150, v151
    v_fmac_f32 v21, v152, v153
    v_fmac_f32 v21, v154, v155
    v_fmac_f32 v21, v156, v157
    v_fmac_f32 v21, v158, v159
    v_min_u32 v20, -2, v20
    v_min_u32 v21, -2, v21
    s_mov_b32 exec_lo, 0x00010001
    s_mov_b32 exec_hi, 0x00010001
    buffer_store_dwordx2 v[20:21], v51, s[12:15], s97 offen sc1
    s_mov_b64 exec, -1
    s_lshl_b32 s66, s52, 7
    s_sub_u32 s97, s97, s66
    s_add_u32 s95, s90, 43008
    s_add_u32 s58, s42, s97
    s_addc_u32 s59, s43, 0
    s_mov_b32 s65, 0
L_bar2:
    s_sleep 24
    s_load_dwordx2 s[92:93], s[42:43], s98 glc
    s_load_dword s60, s[58:59], 28 glc
    s_load_dword s61, s[58:59], 156 glc
    s_load_dword s62, s[58:59], 284 glc
    s_load_dword s63, s[58:59], 412 glc
    s_add_u32 s65, s65, 1
    s_waitcnt lgkmcnt(0)
    s_cmp_gt_u32 s65, 200000
    s_cbranch_scc1 L_bar2go
    s_cmp_eq_u32 s93, 0
    s_cbranch_scc1 L_bar2
    s_max_u32 s60, s60, s61
    s_max_u32 s62, s62, s63
    s_max_u32 s60, s60, s62
    s_cmp_eq_u32 s60, -1
    s_cbranch_scc1 L_bar2
L_bar2go:
    s_mov_b32 s65, 0
    s_mov_b64 vcc, -1
    s_branch L_stpld
L_stp:
    s_sleep 24
L_stpld:
    s_mov_b64 exec, vcc
    buffer_load_dwordx2 v[96:97], v51, s[12:15], s97 offen offset:0 sc1
    buffer_load_dwordx2 v[98:99], v51, s[12:15], s97 offen offset:128 sc1
    buffer_load_dwordx2 v[100:101], v51, s[12:15], s97 offen offset:256 sc1
    buffer_load_dwordx2 v[102:103], v51, s[12:15], s97 offen offset:384 sc1
    buffer_load_dwordx4 v[104:107], v30, s[12:15], s95 offen sc1
    buffer_load_dwordx4 v[108:111], v30, s[12:15], s95 offen offset:64 sc1
    s_add_u32 s65, s65, 1
    s_cmp_gt_u32 s65, 200000
    s_waitcnt vmcnt(0)
    s_cbranch_scc1 L_stpgo
    v_max3_u32 v22, v96, v97, v98
    v_max3_u32 v23, v104, v105, v106
    v_max3_u32 v22, v22, v99, v100
    v_max3_u32 v23, v23, v107, v108
    v_max3_u32 v22, v22, v101, v102
    v_max3_u32 v23, v23, v109, v110
    v_max3_u32 v22, v22, v103, v111
    v_max_u32 v22, v22, v23
    v_cmp_eq_u32 vcc, -1, v22
    s_cbranch_vccnz L_stp
L_stpgo:
    s_mov_b64 exec, -1
    ds_write_b128 v2, v[104:107] offset:26624
    ds_write_b128 v2, v[108:111] offset:27648
    v_max3_f32 v24, v96, v98, v100
    v_max_f32 v24, v24, v102
    v_sub_f32 v96, v96, v24
    v_sub_f32 v98, v98, v24
    v_sub_f32 v100, v100, v24
    v_sub_f32 v102, v102, v24
    v_sub_f32 v20, v20, v24
    v_mul_f32 v96, s69, v96
    v_mul_f32 v98, s69, v98
    v_mul_f32 v100, s69, v100
    v_mul_f32 v102, s69, v102
    v_mul_f32 v20, s69, v20
    v_exp_f32 v96, v96
    v_exp_f32 v98, v98
    v_exp_f32 v100, v100
    v_exp_f32 v102, v102
    v_exp_f32 v20, v20
    v_mul_f32 v21, v96, v97
    v_fmac_f32 v21, v98, v99
    v_fmac_f32 v21, v100, v101
    v_fmac_f32 v21, v102, v103
    v_rcp_f32 v21, v21
    s_nop 0
    v_mul_f32 v20, v20, v21
    v_mul_f32 v144, v20, v144
    v_mul_f32 v146, v20, v146
    v_mul_f32 v148, v20, v148
    v_mul_f32 v150, v20, v150
    v_mul_f32 v152, v20, v152
    v_mul_f32 v154, v20, v154
    v_mul_f32 v156, v20, v156
    v_mul_f32 v158, v20, v158
    v_mul_f32 v12, v158, v12
    v_mul_f32 v13, v158, v13
    v_mul_f32 v14, v158, v14
    v_mul_f32 v15, v158, v15
    v_mul_f32 v16, v158, v16
    v_mul_f32 v17, v158, v17
    v_mul_f32 v18, v158, v18
    v_mul_f32 v19, v158, v19
    s_waitcnt lgkmcnt(0)
    s_add_u32 s66, s90, 32768
    s_add_u32 s58, s42, s66
    s_addc_u32 s59, s43, 0
    v_mov_b32 v3, 0
    s_mov_b32 s66, 0
L_nd:
    ds_read_b32 v22, v3 offset:8
    s_add_u32 s66, s66, 1
    s_waitcnt lgkmcnt(0)
    s_cmp_gt_u32 s66, 1600000
    s_cbranch_scc1 L_ndgo
    v_readfirstlane_b32 s67, v22
    s_nop 0
    s_cmp_eq_u32 s67, 1
    s_cbranch_scc1 L_ndgo
    s_sleep 2
    s_branch L_nd
L_ndgo:
    s_load_dword s60, s[58:59], 0 glc
    s_load_dword s61, s[58:59], 384 glc
    s_load_dword s62, s[58:59], 640 glc
    s_load_dword s63, s[58:59], 1792 glc
    s_load_dword s64, s[58:59], 4224 glc
    s_load_dword s92, s[58:59], 4864 glc
    s_load_dword s93, s[58:59], 5376 glc
    s_load_dword s95, s[58:59], 6016 glc
    s_mov_b32 s66, 0
    s_waitcnt lgkmcnt(0)
    s_cmp_lg_u32 s60, -1
    s_addc_u32 s66, s66, 0
    s_cmp_lg_u32 s61, -1
    s_addc_u32 s66, s66, 0
    s_cmp_lg_u32 s62, -1
    s_addc_u32 s66, s66, 0
    s_cmp_lg_u32 s63, -1
    s_addc_u32 s66, s66, 0
    s_cmp_lg_u32 s64, -1
    s_addc_u32 s66, s66, 0
    s_cmp_lg_u32 s92, -1
    s_addc_u32 s66, s66, 0
    s_cmp_lg_u32 s93, -1
    s_addc_u32 s66, s66, 0
    s_cmp_lg_u32 s95, -1
    s_addc_u32 s66, s66, 0
    s_cmp_ge_u32 s66, 1
    s_cselect_b32 s66, 1, 0
    v_mov_b32 v22, s66
    ds_write_b32 v3, v22 offset:12
    s_waitcnt lgkmcnt(0)
    s_setprio 3
    s_barrier
    ds_read_b128 v[64:67], v2 offset:2048
    ds_read_b128 v[68:71], v2 offset:3072
    ds_read_b128 v[72:75], v2 offset:4096
    ds_read_b128 v[76:79], v2 offset:5120
    ds_read_b128 v[80:83], v2 offset:6144
    ds_read_b128 v[84:87], v2 offset:7168
    ds_read_b128 v[88:91], v2 offset:8192
    ds_read_b128 v[92:95], v2 offset:9216
    ds_read_b128 v[96:99], v2 offset:10240
    ds_read_b128 v[100:103], v2 offset:11264
    ds_read_b128 v[104:107], v2 offset:12288
    ds_read_b128 v[108:111], v2 offset:13312
    ds_read_b128 v[112:115], v2 offset:14336
    ds_read_b128 v[116:119], v2 offset:15360
    s_waitcnt lgkmcnt(12)
    v_fmac_f32 v12, v144, v64
    v_fmac_f32 v13, v144, v65
    v_fmac_f32 v14, v144, v66
    v_fmac_f32 v15, v144, v67
    v_fmac_f32 v16, v144, v68
    v_fmac_f32 v17, v144, v69
    v_fmac_f32 v18, v144, v70
    v_fmac_f32 v19, v144, v71
    s_waitcnt lgkmcnt(10)
    v_fmac_f32 v12, v146, v72
    v_fmac_f32 v13, v146, v73
    v_fmac_f32 v14, v146, v74
    v_fmac_f32 v15, v146, v75
    v_fmac_f32 v16, v146, v76
    v_fmac_f32 v17, v146, v77
    v_fmac_f32 v18, v146, v78
    v_fmac_f32 v19, v146, v79
    s_waitcnt lgkmcnt(8)
    v_fmac_f32 v12, v148, v80
    v_fmac_f32 v13, v148, v81
    v_fmac_f32 v14, v148, v82
    v_fmac_f32 v15, v148, v83
    v_fmac_f32 v16, v148, v84
    v_fmac_f32 v17, v148, v85
    v_fmac_f32 v18, v148, v86
    v_fmac_f32 v19, v148, v87
    s_waitcnt lgkmcnt(6)
    v_fmac_f32 v12, v150, v88
    v_fmac_f32 v13, v150, v89
    v_fmac_f32 v14, v150, v90
    v_fmac_f32 v15, v150, v91
    v_fmac_f32 v16, v150, v92
    v_fmac_f32 v17, v150, v93
    v_fmac_f32 v18, v150, v94
    v_fmac_f32 v19, v150, v95
    s_waitcnt lgkmcnt(4)
    v_fmac_f32 v12, v152, v96
    v_fmac_f32 v13, v152, v97
    v_fmac_f32 v14, v152, v98
    v_fmac_f32 v15, v152, v99
    v_fmac_f32 v16, v152, v100
    v_fmac_f32 v17, v152, v101
    v_fmac_f32 v18, v152, v102
    v_fmac_f32 v19, v152, v103
    s_waitcnt lgkmcnt(2)
    v_fmac_f32 v12, v154, v104
    v_fmac_f32 v13, v154, v105
    v_fmac_f32 v14, v154, v106
    v_fmac_f32 v15, v154, v107
    v_fmac_f32 v16, v154, v108
    v_fmac_f32 v17, v154, v109
    v_fmac_f32 v18, v154, v110
    v_fmac_f32 v19, v154, v111
    s_waitcnt lgkmcnt(0)
    v_fmac_f32 v12, v156, v112
    v_fmac_f32 v13, v156, v113
    v_fmac_f32 v14, v156, v114
    v_fmac_f32 v15, v156, v115
    v_fmac_f32 v16, v156, v116
    v_fmac_f32 v17, v156, v117
    v_fmac_f32 v18, v156, v118
    v_fmac_f32 v19, v156, v119
    v_cvt_pk_bf16_f32 v24, v12, v13
    v_cvt_pk_bf16_f32 v25, v14, v15
    v_cvt_pk_bf16_f32 v26, v16, v17
    v_cvt_pk_bf16_f32 v27, v18, v19
    v_min_u32 v24, -2, v24
    v_min_u32 v25, -2, v25
    v_min_u32 v26, -2, v26
    v_min_u32 v27, -2, v27
    buffer_store_dwordx4 v[24:27], v50, s[12:15], s96 offen sc1
    s_barrier
    s_barrier
L_end:
    s_endpgm
.section .rodata,"a"
.p2align 6
.amdhsa_kernel gated_mix__gqa_block_cached__dense_activation_squared_relu__decode_kernel
  .amdhsa_next_free_vgpr 256
  .amdhsa_next_free_sgpr 102
  .amdhsa_accum_offset 256
  .amdhsa_group_segment_fixed_size 0
  .amdhsa_kernarg_size 112
  .amdhsa_user_sgpr_count 2
  .amdhsa_user_sgpr_kernarg_segment_ptr 1
  .amdhsa_system_sgpr_workgroup_id_x 1
.end_amdhsa_kernel
```
